```python
import torch

def _softmax(x, axis=-1):
    return torch.softmax(x, dim=axis)

def _gelu(x):
    return torch.nn.functional.gelu(x, approximate='tanh')

def _silu(x):
    return torch.nn.functional.silu(x)

def _sigmoid(x):
    return torch.sigmoid(x)

def _layernorm(x, axis=-1, eps=1e-05):
    m = x.mean(dim=axis, keepdim=True)
    v = x.var(dim=axis, keepdim=True, unbiased=False)
    return (x - m) / torch.sqrt(v + eps)

def _scatter_add(tgt, idx, src, axis=0):
    return tgt.clone().index_add_(axis, idx, src)

def _segment_sum(src, seg, n):
    out = torch.zeros((n,) + src.shape[1:], dtype=src.dtype)
    return out.index_add_(0, seg, src)

def _pad(x, pw):
    flat = tuple((v for pair in reversed(pw) for v in pair))
    return torch.nn.functional.pad(x, flat)
kernel_name = 'adaLN_cond__gqa_block_cached__dense_activation_silu__decode'

def setup_inputs():

    _w = lambda a: (lambda t: t.to(torch.bfloat16) if t.is_floating_point() else t)(torch.as_tensor(a))

    def _A_setup():
        B, Sq, D = (2, 1, 512)
        Hq, Hkv, Sk, Dh = (32, 32, 4096, 128)
        assert Hq % Hkv == 0, (Hq, Hkv)
        return {'x': _w((lambda *s: torch.randn(*s, dtype=torch.bfloat16) * 0.1)(B, Sq, D)), 'k_cache': _w((lambda *s: torch.randn(*s, dtype=torch.bfloat16) * 0.8)(B, Hkv, Sk, Dh)), 'v_cache': _w((lambda *s: torch.randn(*s, dtype=torch.bfloat16) * 3.2)(B, Hkv, Sk, Dh)), 'wq': _w((lambda *s: torch.randn(*s, dtype=torch.bfloat16) * 0.8)(D, Hq * Dh) * D ** (-0.5)), 'wo': _w((lambda *s: torch.randn(*s, dtype=torch.bfloat16) * 3.2)(Hq * Dh, D) * (Hq * Dh) ** (-0.5))}
    _A_in = _A_setup()

    def _B_setup():
        B, S, D, F = (2, 1, 512, 1376)
        return {'x': _w((lambda *s: torch.randn(*s, dtype=torch.bfloat16) * 0.1)(B, S, D)), 'w1': _w((lambda *s: torch.randn(*s, dtype=torch.bfloat16) * 3.2)(D, F) * D ** (-0.5)), 'w2': _w((lambda *s: torch.randn(*s, dtype=torch.bfloat16) * 3.2)(F, D) * F ** (-0.5))}
    _B_in = _B_setup()
    return {'A_x': _A_in['x'], 'A_k_cache': _A_in['k_cache'], 'A_v_cache': _A_in['v_cache'], 'A_wq': _A_in['wq'], 'A_wo': _A_in['wo'], 'B_x': _B_in['x'], 'B_w1': _B_in['w1'], 'B_w2': _B_in['w2'], 'c': _w((lambda *s: torch.randn(*s, dtype=torch.bfloat16) * 0.2)(2, 512) * 8.0), 'w_mod': _w((lambda *s: torch.randn(*s, dtype=torch.bfloat16) * 0.2)(512, 6 * 512) * 512 ** (-0.5) * 8.0)}

def reference(A_x, A_k_cache, A_v_cache, A_wq, A_wo, B_x, B_w1, B_w2, c, w_mod):

    def _A_ref(x, k_cache, v_cache, wq, wo):
        B, Sq, D = x.shape
        Hq, Dh = (32, 128)
        Hkv = k_cache.shape[1]
        rep = Hq // Hkv
        q = (lambda x, *d: x.permute(*d))((x @ wq).reshape(B, Sq, Hq, Dh), 0, 2, 1, 3)
        k = (lambda x, n, axis: torch.repeat_interleave(x, n, dim=axis))(k_cache, rep, axis=1)
        v = (lambda x, n, axis: torch.repeat_interleave(x, n, dim=axis))(v_cache, rep, axis=1)
        scores = torch.einsum('bhqd,bhkd->bhqk', q, k) * Dh ** (-0.5)
        p = _softmax(scores, axis=-1)
        o = torch.einsum('bhqk,bhkd->bhqd', p, v)
        return (lambda x, *d: x.permute(*d))(o, 0, 2, 1, 3).reshape(B, Sq, Hq * Dh) @ wo

    def _B_ref(x, w1, w2):
        h = torch.einsum('bsd,df->bsf', x, w1)
        h = _silu(h)
        out = torch.einsum('bsf,fd->bsd', h, w2)
        return out
    x = A_x
    mod = (_silu(c) @ w_mod).reshape(c.shape[0], 6, 1, -1)
    sa, ca, ga, sb, cb, gb = (mod[:, 0].clone(), mod[:, 1].clone(), mod[:, 2].clone(), mod[:, 3].clone(), mod[:, 4].clone(), mod[:, 5].clone())
    h = _layernorm(x, axis=-1) * (1 + ca) + sa
    x = x + ga * _A_ref(h, A_k_cache, A_v_cache, A_wq, A_wo)
    h = _layernorm(x, axis=-1) * (1 + cb) + sb
    x = x + gb * _B_ref(h, B_w1, B_w2)
    return x
```

```asm
; @launch grid=(256,1,1) block=(768,1,1) lds=151552
.amdgcn_target "amdgcn-amd-amdhsa--gfx950"
.text
.globl adaLN_cond__gqa_block_cached__dense_activation_silu__decode_kernel
.p2align 8
.type adaLN_cond__gqa_block_cached__dense_activation_silu__decode_kernel,@function
adaLN_cond__gqa_block_cached__dense_activation_silu__decode_kernel:
    s_cmp_ge_u32 s2, 256
    s_cbranch_scc1 L_exit
    s_load_dwordx16 s[16:31], s[0:1], 0
    s_load_dwordx8 s[32:39], s[0:1], 64
    s_load_dwordx2 s[40:41], s[0:1], 96
    v_lshrrev_b32 v1, 6, v0
    v_and_b32 v0, 63, v0
    v_readfirstlane_b32 s3, v1
    s_and_b32 s9, s2, 7
    s_lshr_b32 s8, s2, 3
    s_lshl_b32 s4, s9, 2
    s_lshr_b32 s10, s8, 3
    s_add_u32 s4, s4, s10
    s_and_b32 s7, s8, 7
    s_lshr_b32 s5, s7, 2
    s_and_b32 s6, s7, 3
    s_lshr_b32 s56, s7, 1
    s_lshl_b32 s57, s10, 2
    s_add_u32 s57, s57, s56
    s_lshl_b32 s58, s57, 2
    s_lshr_b32 s11, s9, 1
    s_add_u32 s58, s58, s11
    s_and_b32 s59, s7, 1
    s_xor_b32 s59, s59, 1
    s_cmp_lg_u32 s3, 0
    s_cbranch_scc1 L_noinit
    v_mov_b32 v2, 0
    v_lshlrev_b32 v3, 2, v0
    v_add_u32 v3, 131072, v3
    ds_write_b32 v3, v2
L_noinit:
    s_waitcnt lgkmcnt(0)
    s_load_dword s42, s[40:41], 0
    s_mov_b32 s52, s40
    s_and_b32 s53, s41, 0xffff
    s_mov_b32 s54, 0x200000
    s_mov_b32 s55, 0x20000
    v_mov_b32 v3, 131072
    s_barrier
    s_cmp_ge_u32 s3, 4
    s_cbranch_scc1 L_stream
    s_setprio 3
    s_cmp_eq_u32 s3, 1
    s_cbranch_scc1 L_h1
    s_cmp_eq_u32 s3, 2
    s_cbranch_scc1 L_h2
    s_cmp_eq_u32 s3, 3
    s_cbranch_scc1 L_h3
L_h0:
    s_lshr_b32 s10, s9, 1
    s_lshl_b32 s62, s8, 2
    s_add_u32 s62, s62, s10
    s_lshr_b32 s60, s62, 2
    s_and_b32 s61, s62, 3
    s_bitcmp1_b32 s9, 0
    s_cbranch_scc0 L_h0_job
    s_lshr_b32 s11, s8, 1
    s_lshl_b32 s62, s11, 2
    s_add_u32 s62, s62, s10
    s_cmp_eq_u32 s59, 0
    s_cbranch_scc1 L_h0_nojob
    s_branch L_h0_nojob
L_h0_job:
    s_mov_b32 s44, s34
    s_and_b32 s45, s35, 0xffff
    s_mov_b32 s46, 0x300000
    s_mov_b32 s47, 0x20000
    s_mov_b32 s48, s32
    s_and_b32 s49, s33, 0xffff
    s_mov_b32 s50, 0x800
    s_mov_b32 s51, 0x20000
    v_lshrrev_b32 v4, 3, v0
    v_mul_u32_u24 v12, 6144, v4
    v_bfe_u32 v4, v0, 4, 1
    v_lshlrev_b32 v4, 1, v4
    v_and_b32 v6, 7, v0
    v_xor_b32 v4, v4, v6
    v_lshlrev_b32 v4, 4, v4
    v_xor_b32 v6, 0x40, v4
    v_add_u32 v13, v12, v6
    v_add_u32 v12, v12, v4
    v_lshrrev_b32 v4, 5, v0
    v_lshlrev_b32 v2, 10, v4
    v_and_b32 v5, 31, v0
    v_lshlrev_b32 v5, 3, v5
    v_add_u32 v2, v2, v5
    s_mov_b32 s63, 0
L_h0_again:
    s_lshl_b32 s10, s61, 8
    buffer_load_dwordx2 v[8:9], v2, s[48:51], s10 offen
    s_mul_i32 s11, s61, 786432
    s_lshl_b32 s10, s60, 7
    s_add_u32 s10, s10, s11
    s_mov_b32 m0, 16384
    s_add_u32 s11, s10, 0
    buffer_load_dwordx4 v12, s[44:47], s11 offen nt lds
    s_mov_b32 m0, 17408
    s_add_u32 s11, s10, 49152
    buffer_load_dwordx4 v13, s[44:47], s11 offen nt lds
    s_mov_b32 m0, 18432
    s_add_u32 s11, s10, 98304
    buffer_load_dwordx4 v12, s[44:47], s11 offen nt lds
    s_mov_b32 m0, 19456
    s_add_u32 s11, s10, 147456
    buffer_load_dwordx4 v13, s[44:47], s11 offen nt lds
    s_mov_b32 m0, 20480
    s_add_u32 s11, s10, 196608
    buffer_load_dwordx4 v12, s[44:47], s11 offen nt lds
    s_mov_b32 m0, 21504
    s_add_u32 s11, s10, 245760
    buffer_load_dwordx4 v13, s[44:47], s11 offen nt lds
    s_mov_b32 m0, 22528
    s_add_u32 s11, s10, 294912
    buffer_load_dwordx4 v12, s[44:47], s11 offen nt lds
    s_mov_b32 m0, 23552
    s_add_u32 s11, s10, 344064
    buffer_load_dwordx4 v13, s[44:47], s11 offen nt lds
    s_mov_b32 m0, 24576
    s_add_u32 s11, s10, 393216
    buffer_load_dwordx4 v12, s[44:47], s11 offen nt lds
    s_mov_b32 m0, 25600
    s_add_u32 s11, s10, 442368
    buffer_load_dwordx4 v13, s[44:47], s11 offen nt lds
    s_mov_b32 m0, 26624
    s_add_u32 s11, s10, 491520
    buffer_load_dwordx4 v12, s[44:47], s11 offen nt lds
    s_mov_b32 m0, 27648
    s_add_u32 s11, s10, 540672
    buffer_load_dwordx4 v13, s[44:47], s11 offen nt lds
    s_mov_b32 m0, 28672
    s_add_u32 s11, s10, 589824
    buffer_load_dwordx4 v12, s[44:47], s11 offen nt lds
    s_mov_b32 m0, 29696
    s_add_u32 s11, s10, 638976
    buffer_load_dwordx4 v13, s[44:47], s11 offen nt lds
    s_mov_b32 m0, 30720
    s_add_u32 s11, s10, 688128
    buffer_load_dwordx4 v12, s[44:47], s11 offen nt lds
    s_mov_b32 m0, 31744
    s_add_u32 s11, s10, 737280
    buffer_load_dwordx4 v13, s[44:47], s11 offen nt lds
    v_and_b32 v5, 31, v0
    v_lshlrev_b32 v5, 3, v5
    v_lshrrev_b32 v4, 5, v0
    v_mul_u32_u24 v4, 272, v4
    v_add_u32 v5, v5, v4
    v_add_u32 v5, 136192, v5
    v_and_b32 v4, 1, v0
    v_mul_u32_u24 v6, 272, v4
    v_lshrrev_b32 v7, 4, v0
    v_lshlrev_b32 v7, 4, v7
    v_add_u32 v6, v6, v7
    v_add_u32 v6, 136192, v6
    v_lshlrev_b32 v4, 8, v4
    v_add_u32 v7, v7, v4
    v_bfe_u32 v4, v0, 1, 2
    v_lshlrev_b32 v4, 6, v4
    v_add_u32 v7, v7, v4
    v_lshrrev_b32 v4, 4, v0
    v_bfe_u32 v10, v0, 2, 2
    v_lshlrev_b32 v11, 3, v4
    v_add_u32 v11, v11, v10
    v_lshlrev_b32 v11, 7, v11
    v_and_b32 v4, 1, v4
    v_lshlrev_b32 v4, 1, v4
    v_lshrrev_b32 v10, 1, v10
    v_or_b32 v4, v4, v10
    v_lshlrev_b32 v4, 5, v4
    v_and_b32 v10, 1, v0
    v_lshlrev_b32 v10, 3, v10
    v_add_u32 v11, v11, v10
    v_bfe_u32 v10, v0, 1, 1
    v_lshlrev_b32 v10, 4, v10
    v_add_u32 v11, v11, v10
    v_add_u32 v11, 16384, v11
    v_xor_b32 v10, 0, v4
    v_add_u32 v24, v11, v10
    v_xor_b32 v10, 32, v4
    v_add_u32 v25, v11, v10
    v_xor_b32 v10, 64, v4
    v_add_u32 v26, v11, v10
    v_xor_b32 v10, 96, v4
    v_add_u32 v27, v11, v10
    s_waitcnt lgkmcnt(0)
    s_mul_i32 s43, s42, 1664525
    s_add_u32 s43, s43, 1013904223
    s_mov_b32 s72, 0x05040100
    s_mov_b32 s73, 0x0c0c0400
    s_mov_b32 s74, 0x04000c0c
    s_mov_b32 s75, 0xffff0000
    s_mov_b32 s76, 0xffffff00
    s_and_b32 s77, s43, 0xffff
    s_lshr_b32 s78, s43, 16
    s_bfe_u32 s10, s43, 0x80000
    v_mov_b32 v28, s10
    s_bfe_u32 s10, s43, 0x80008
    v_mov_b32 v29, s10
    s_bfe_u32 s10, s43, 0x80010
    v_mov_b32 v30, s10
    s_bfe_u32 s10, s43, 0x80018
    v_mov_b32 v31, s10
    s_waitcnt vmcnt(16)
    v_lshlrev_b32 v16, 16, v8
    v_and_b32 v17, 0xffff0000, v8
    v_lshlrev_b32 v18, 16, v9
    v_and_b32 v19, 0xffff0000, v9
    v_mul_f32 v20, 0xbfb8aa3b, v16
    v_mul_f32 v21, 0xbfb8aa3b, v17
    v_mul_f32 v22, 0xbfb8aa3b, v18
    v_mul_f32 v23, 0xbfb8aa3b, v19
    v_exp_f32 v20, v20
    v_exp_f32 v21, v21
    v_exp_f32 v22, v22
    v_exp_f32 v23, v23
    v_add_f32 v20, 1.0, v20
    v_add_f32 v21, 1.0, v21
    v_add_f32 v22, 1.0, v22
    v_add_f32 v23, 1.0, v23
    v_rcp_f32 v20, v20
    v_rcp_f32 v21, v21
    v_rcp_f32 v22, v22
    v_rcp_f32 v23, v23
    v_mul_f32 v16, v16, v20
    v_mul_f32 v17, v17, v21
    v_mul_f32 v18, v18, v22
    v_mul_f32 v19, v19, v23
    v_cvt_pk_bf16_f32 v16, v16, v17
    v_cvt_pk_bf16_f32 v17, v18, v19
    ds_write_b64 v5, v[16:17]
    ds_read_b128 v[32:35], v6 offset:0
    ds_read_b128 v[36:39], v6 offset:64
    ds_read_b128 v[40:43], v6 offset:128
    ds_read_b128 v[44:47], v6 offset:192
    s_waitcnt vmcnt(0) lgkmcnt(0)
    ds_read_b64_tr_b16 v[64:65], v24 offset:0
    ds_read_b64_tr_b16 v[66:67], v24 offset:512
    ds_read_b64_tr_b16 v[68:69], v25 offset:0
    ds_read_b64_tr_b16 v[70:71], v25 offset:512
    ds_read_b64_tr_b16 v[72:73], v26 offset:0
    ds_read_b64_tr_b16 v[74:75], v26 offset:512
    ds_read_b64_tr_b16 v[76:77], v27 offset:0
    ds_read_b64_tr_b16 v[78:79], v27 offset:512
    s_waitcnt lgkmcnt(4)
    ds_read_b64_tr_b16 v[80:81], v24 offset:4096
    ds_read_b64_tr_b16 v[82:83], v24 offset:4608
    ds_read_b64_tr_b16 v[84:85], v25 offset:4096
    ds_read_b64_tr_b16 v[86:87], v25 offset:4608
    ds_read_b64_tr_b16 v[88:89], v26 offset:4096
    ds_read_b64_tr_b16 v[90:91], v26 offset:4608
    ds_read_b64_tr_b16 v[92:93], v27 offset:4096
    ds_read_b64_tr_b16 v[94:95], v27 offset:4608
    s_waitcnt lgkmcnt(8)
    v_mfma_f32_16x16x32_bf16 v[48:51], v[64:67], v[32:35], 0
    v_mfma_f32_16x16x32_bf16 v[52:55], v[68:71], v[32:35], 0
    v_mfma_f32_16x16x32_bf16 v[56:59], v[72:75], v[32:35], 0
    v_mfma_f32_16x16x32_bf16 v[60:63], v[76:79], v[32:35], 0
    s_waitcnt lgkmcnt(4)
    ds_read_b64_tr_b16 v[64:65], v24 offset:8192
    ds_read_b64_tr_b16 v[66:67], v24 offset:8704
    ds_read_b64_tr_b16 v[68:69], v25 offset:8192
    ds_read_b64_tr_b16 v[70:71], v25 offset:8704
    ds_read_b64_tr_b16 v[72:73], v26 offset:8192
    ds_read_b64_tr_b16 v[74:75], v26 offset:8704
    ds_read_b64_tr_b16 v[76:77], v27 offset:8192
    ds_read_b64_tr_b16 v[78:79], v27 offset:8704
    s_waitcnt lgkmcnt(8)
    v_mfma_f32_16x16x32_bf16 v[48:51], v[80:83], v[36:39], v[48:51]
    v_mfma_f32_16x16x32_bf16 v[52:55], v[84:87], v[36:39], v[52:55]
    v_mfma_f32_16x16x32_bf16 v[56:59], v[88:91], v[36:39], v[56:59]
    v_mfma_f32_16x16x32_bf16 v[60:63], v[92:95], v[36:39], v[60:63]
    s_waitcnt lgkmcnt(4)
    ds_read_b64_tr_b16 v[80:81], v24 offset:12288
    ds_read_b64_tr_b16 v[82:83], v24 offset:12800
    ds_read_b64_tr_b16 v[84:85], v25 offset:12288
    ds_read_b64_tr_b16 v[86:87], v25 offset:12800
    ds_read_b64_tr_b16 v[88:89], v26 offset:12288
    ds_read_b64_tr_b16 v[90:91], v26 offset:12800
    ds_read_b64_tr_b16 v[92:93], v27 offset:12288
    ds_read_b64_tr_b16 v[94:95], v27 offset:12800
    s_waitcnt lgkmcnt(8)
    v_mfma_f32_16x16x32_bf16 v[48:51], v[64:67], v[40:43], v[48:51]
    v_mfma_f32_16x16x32_bf16 v[52:55], v[68:71], v[40:43], v[52:55]
    v_mfma_f32_16x16x32_bf16 v[56:59], v[72:75], v[40:43], v[56:59]
    v_mfma_f32_16x16x32_bf16 v[60:63], v[76:79], v[40:43], v[60:63]
    s_waitcnt lgkmcnt(0)
    v_mfma_f32_16x16x32_bf16 v[48:51], v[80:83], v[44:47], v[48:51]
    v_mfma_f32_16x16x32_bf16 v[52:55], v[84:87], v[44:47], v[52:55]
    v_mfma_f32_16x16x32_bf16 v[56:59], v[88:91], v[44:47], v[56:59]
    v_mfma_f32_16x16x32_bf16 v[60:63], v[92:95], v[44:47], v[60:63]
    s_mov_b32 s10, 0x000c000c
    s_mov_b32 s11, 0x000c000c
    s_nop 3
    v_cndmask_b32_e64 v16, v48, v52, s[10:11]
    v_cndmask_b32_e64 v17, v49, v53, s[10:11]
    v_cndmask_b32_e64 v18, v50, v54, s[10:11]
    v_cndmask_b32_e64 v19, v51, v55, s[10:11]
    s_lshl_b64 s[10:11], s[10:11], 2
    v_cndmask_b32_e64 v16, v16, v56, s[10:11]
    v_cndmask_b32_e64 v17, v17, v57, s[10:11]
    v_cndmask_b32_e64 v18, v18, v58, s[10:11]
    v_cndmask_b32_e64 v19, v19, v59, s[10:11]
    s_lshl_b64 s[10:11], s[10:11], 2
    v_cndmask_b32_e64 v16, v16, v60, s[10:11]
    v_cndmask_b32_e64 v17, v17, v61, s[10:11]
    v_cndmask_b32_e64 v18, v18, v62, s[10:11]
    v_cndmask_b32_e64 v19, v19, v63, s[10:11]
    v_bfi_b32 v16, s76, v16, v28
    v_bfi_b32 v17, s76, v17, v29
    v_bfi_b32 v18, s76, v18, v30
    v_bfi_b32 v19, s76, v19, v31
    s_lshl_b32 s10, s60, 11
    s_lshl_b32 s11, s61, 9
    s_add_u32 s10, s10, s11
    s_add_u32 s10, s10, 32768
    s_mov_b32 exec_lo, 0x00ff00ff
    s_mov_b32 exec_hi, 0x00ff00ff
    buffer_store_dwordx4 v[16:19], v7, s[52:55], s10 offen sc1
    s_mov_b64 exec, -1
    s_cmp_lg_u32 s63, 0
    s_cbranch_scc1 L_h0_jobs_done
    s_cmp_lt_u32 s8, 16
    s_cbranch_scc1 L_h0_jobs_done
    s_mov_b32 s63, 1
    s_add_u32 s60, s8, 16
    s_branch L_h0_again
L_h0_jobs_done:
    v_mov_b32 v4, 1
    s_mov_b64 exec, 1
    ds_write_b32 v3, v4 offset:32
    s_mov_b64 exec, -1
    s_branch L_tail
L_h0_nojob:
    v_mov_b32 v4, 1
    s_mov_b64 exec, 1
    ds_write_b32 v3, v4 offset:32
    s_mov_b64 exec, -1
    s_waitcnt lgkmcnt(0)
    s_mul_i32 s43, s42, 1664525
    s_add_u32 s43, s43, 1013904223
    s_mov_b32 s72, 0x05040100
    s_mov_b32 s73, 0x0c0c0400
    s_mov_b32 s74, 0x04000c0c
    s_mov_b32 s75, 0xffff0000
    s_mov_b32 s76, 0xffffff00
    s_and_b32 s77, s43, 0xffff
    s_lshr_b32 s78, s43, 16
    s_cmp_lg_u32 s59, 0
    s_cbranch_scc1 L_tail
    s_cmp_ge_u32 s62, 32
    s_cbranch_scc1 L_tail
    s_add_u32 s60, s62, 16
    s_lshl_b32 s62, s60, 11
    s_add_u32 s62, s62, 32768
    v_lshlrev_b32 v4, 4, v0
    s_mov_b32 s15, 65536
L_lw_1:
    ds_read_b32 v5, v3 offset:0
    s_waitcnt lgkmcnt(0)
    v_readfirstlane_b32 s14, v5
    s_nop 0
    s_cmp_lg_u32 s14, 0
    s_cbranch_scc1 L_lwd_2
    s_sub_u32 s15, s15, 1
    s_cmp_eq_u32 s15, 0
    s_cbranch_scc1 L_abort
    s_sleep 8
    s_branch L_lw_1
L_lwd_2:
    s_mov_b64 s[64:65], -1
    s_mov_b64 s[66:67], -1
    s_mov_b32 s15, 65536
L_mpoll_3:
    s_mov_b64 exec, s[64:65]
    buffer_load_dwordx4 v[8:11], v4, s[52:55], s62 offen sc1
    s_mov_b64 exec, s[66:67]
    s_add_u32 s13, s62, 1024
    buffer_load_dwordx4 v[12:15], v4, s[52:55], s13 offen sc1
    s_mov_b64 exec, -1
    s_waitcnt vmcnt(0)
    v_perm_b32 v5, v9, v8, s73
    v_perm_b32 v6, v11, v10, s74
    v_or_b32 v5, v5, v6
    v_cmp_ne_u32 s[64:65], s43, v5
    v_perm_b32 v5, v13, v12, s73
    v_perm_b32 v6, v15, v14, s74
    v_or_b32 v5, v5, v6
    v_cmp_ne_u32 s[66:67], s43, v5
    s_mov_b64 s[10:11], s[64:65]
    s_or_b64 s[10:11], s[10:11], s[66:67]
    s_cmp_eq_u64 s[10:11], 0
    s_cbranch_scc1 L_mpolld_4
    s_sub_u32 s15, s15, 1
    s_cmp_eq_u32 s15, 0
    s_cbranch_scc1 L_abort
    s_sleep 8
    s_branch L_mpoll_3
L_mpolld_4:
    v_and_b32 v8, s76, v8
    v_and_b32 v9, s76, v9
    v_and_b32 v10, s76, v10
    v_and_b32 v11, s76, v11
    v_and_b32 v12, s76, v12
    v_and_b32 v13, s76, v13
    v_and_b32 v14, s76, v14
    v_and_b32 v15, s76, v15
    v_add_f32 v8, v8, v12
    v_add_f32 v9, v9, v13
    v_add_f32 v10, v10, v14
    v_add_f32 v11, v11, v15
    v_mov_b32 v12, v8
    v_mov_b32 v13, v9
    v_mov_b32 v14, v10
    v_mov_b32 v15, v11
    v_permlane32_swap_b32 v8, v12
    v_permlane32_swap_b32 v9, v13
    v_permlane32_swap_b32 v10, v14
    v_permlane32_swap_b32 v11, v15
    v_add_f32 v8, v8, v12
    v_add_f32 v9, v9, v13
    v_add_f32 v10, v10, v14
    v_add_f32 v11, v11, v15
    v_cvt_pk_bf16_f32 v8, v8, v8
    v_cvt_pk_bf16_f32 v9, v9, v9
    v_cvt_pk_bf16_f32 v10, v10, v10
    v_cvt_pk_bf16_f32 v11, v11, v11
    v_mov_b32 v5, s77
    v_bfi_b32 v8, s75, v8, v5
    v_mov_b32 v5, s78
    v_bfi_b32 v9, s75, v9, v5
    v_mov_b32 v5, s77
    v_bfi_b32 v10, s75, v10, v5
    v_mov_b32 v5, s78
    v_bfi_b32 v11, s75, v11, v5
    v_bfe_u32 v4, v0, 3, 1
    v_lshlrev_b32 v4, 8, v4
    v_bfe_u32 v5, v0, 4, 1
    v_lshlrev_b32 v5, 7, v5
    v_and_b32 v6, 7, v0
    v_lshlrev_b32 v6, 4, v6
    v_add3_u32 v4, v4, v5, v6
    s_lshl_b32 s10, s60, 9
    s_add_u32 s10, s10, 4096
    s_mov_b32 exec_hi, 0
    buffer_store_dwordx4 v[8:11], v4, s[52:55], s10 offen sc1
    s_mov_b64 exec, -1
    s_branch L_tail
L_h1:
    s_mov_b32 s44, s22
    s_and_b32 s45, s23, 0xffff
    s_mov_b32 s46, 0x400000
    s_mov_b32 s47, 0x20000
    s_mov_b32 s48, s16
    s_and_b32 s49, s17, 0xffff
    s_mov_b32 s50, 0x800
    s_mov_b32 s51, 0x20000
    v_lshlrev_b32 v2, 4, v0
    buffer_load_dwordx4 v[8:11], v2, s[48:51], 0 offen
    buffer_load_dwordx4 v[12:15], v2, s[48:51], 0 offen offset:1024
    v_bfe_u32 v4, v0, 4, 1
    v_lshlrev_b32 v4, 10, v4
    v_and_b32 v6, 15, v0
    v_lshlrev_b32 v6, 3, v6
    v_add_u32 v4, v4, v6
    s_lshl_b32 s10, s7, 7
    buffer_load_dwordx2 v[16:17], v4, s[48:51], s10 offen
    v_lshrrev_b32 v4, 4, v0
    v_lshlrev_b32 v5, 13, v4
    v_lshlrev_b32 v4, 5, v4
    v_and_b32 v6, 15, v0
    v_lshlrev_b32 v6, 4, v6
    v_xor_b32 v6, v6, v4
    v_add_u32 v18, v5, v6
    v_xor_b32 v6, 0x80, v6
    v_add_u32 v19, v5, v6
    s_lshl_b32 s10, s7, 19
    s_lshl_b32 s11, s4, 8
    s_add_u32 s10, s10, s11
    s_mov_b32 m0, 0
    s_add_u32 s11, s10, 0
    buffer_load_dwordx4 v18, s[44:47], s11 offen nt lds
    s_mov_b32 m0, 1024
    s_add_u32 s11, s10, 32768
    buffer_load_dwordx4 v18, s[44:47], s11 offen nt lds
    s_mov_b32 m0, 2048
    s_add_u32 s11, s10, 65536
    buffer_load_dwordx4 v19, s[44:47], s11 offen nt lds
    s_mov_b32 m0, 3072
    s_add_u32 s11, s10, 98304
    buffer_load_dwordx4 v19, s[44:47], s11 offen nt lds
    s_mov_b32 m0, 4096
    s_add_u32 s11, s10, 131072
    buffer_load_dwordx4 v18, s[44:47], s11 offen nt lds
    s_mov_b32 m0, 5120
    s_add_u32 s11, s10, 163840
    buffer_load_dwordx4 v18, s[44:47], s11 offen nt lds
    s_mov_b32 m0, 6144
    s_add_u32 s11, s10, 196608
    buffer_load_dwordx4 v19, s[44:47], s11 offen nt lds
    s_mov_b32 m0, 7168
    s_add_u32 s11, s10, 229376
    buffer_load_dwordx4 v19, s[44:47], s11 offen nt lds
    s_mov_b32 m0, 8192
    s_add_u32 s11, s10, 262144
    buffer_load_dwordx4 v18, s[44:47], s11 offen nt lds
    s_mov_b32 m0, 9216
    s_add_u32 s11, s10, 294912
    buffer_load_dwordx4 v18, s[44:47], s11 offen nt lds
    s_mov_b32 m0, 10240
    s_add_u32 s11, s10, 327680
    buffer_load_dwordx4 v19, s[44:47], s11 offen nt lds
    s_mov_b32 m0, 11264
    s_add_u32 s11, s10, 360448
    buffer_load_dwordx4 v19, s[44:47], s11 offen nt lds
    s_mov_b32 m0, 12288
    s_add_u32 s11, s10, 393216
    buffer_load_dwordx4 v18, s[44:47], s11 offen nt lds
    s_mov_b32 m0, 13312
    s_add_u32 s11, s10, 425984
    buffer_load_dwordx4 v18, s[44:47], s11 offen nt lds
    s_mov_b32 m0, 14336
    s_add_u32 s11, s10, 458752
    buffer_load_dwordx4 v19, s[44:47], s11 offen nt lds
    s_mov_b32 m0, 15360
    s_add_u32 s11, s10, 491520
    buffer_load_dwordx4 v19, s[44:47], s11 offen nt lds
    s_waitcnt lgkmcnt(0)
    s_mul_i32 s43, s42, 1664525
    s_add_u32 s43, s43, 1013904223
    s_mov_b32 s72, 0x05040100
    s_mov_b32 s73, 0x0c0c0400
    s_mov_b32 s74, 0x04000c0c
    s_mov_b32 s75, 0xffff0000
    s_mov_b32 s76, 0xffffff00
    s_and_b32 s77, s43, 0xffff
    s_lshr_b32 s78, s43, 16
    s_waitcnt vmcnt(16)
    s_bfe_u32 s10, s43, 0x80000
    v_mov_b32 v92, s10
    s_bfe_u32 s10, s43, 0x80008
    v_mov_b32 v93, s10
    s_bfe_u32 s10, s43, 0x80010
    v_mov_b32 v94, s10
    s_bfe_u32 s10, s43, 0x80018
    v_mov_b32 v95, s10
    s_getreg_b32 s71, hwreg(HW_REG_XCC_ID)
    s_and_b32 s71, s71, 15
    s_lshl_b32 s10, s71, 8
    v_or_b32 v92, s10, v92
    s_lshl_b32 s70, s4, 7
    s_add_u32 s70, s70, 425984
    s_lshl_b32 s10, s7, 4
    v_mov_b32 v4, s10
    s_mov_b64 exec, 1
    buffer_store_dwordx4 v[92:95], v4, s[52:55], s70 offen sc1
    s_mov_b64 exec, -1
    v_lshlrev_b32 v24, 16, v8
    v_and_b32 v25, 0xffff0000, v8
    v_lshlrev_b32 v26, 16, v9
    v_and_b32 v27, 0xffff0000, v9
    v_lshlrev_b32 v28, 16, v10
    v_and_b32 v29, 0xffff0000, v10
    v_lshlrev_b32 v30, 16, v11
    v_and_b32 v31, 0xffff0000, v11
    v_lshlrev_b32 v32, 16, v12
    v_and_b32 v33, 0xffff0000, v12
    v_lshlrev_b32 v34, 16, v13
    v_and_b32 v35, 0xffff0000, v13
    v_lshlrev_b32 v36, 16, v14
    v_and_b32 v37, 0xffff0000, v14
    v_lshlrev_b32 v38, 16, v15
    v_and_b32 v39, 0xffff0000, v15
    v_add_f32 v40, v24, v25
    v_add_f32 v42, v26, v27
    v_add_f32 v43, v28, v29
    v_add_f32 v44, v30, v31
    v_add_f32 v40, v40, v42
    v_add_f32 v43, v43, v44
    v_add_f32 v40, v40, v43
    v_add_f32 v41, v32, v33
    v_add_f32 v42, v34, v35
    v_add_f32 v43, v36, v37
    v_add_f32 v44, v38, v39
    v_add_f32 v41, v41, v42
    v_add_f32 v43, v43, v44
    v_add_f32 v41, v41, v43
    v_add_f32_dpp v40, v40, v40 row_ror:1 row_mask:0xf bank_mask:0xf
    s_nop 0
    v_add_f32_dpp v41, v41, v41 row_ror:1 row_mask:0xf bank_mask:0xf
    v_add_f32_dpp v40, v40, v40 row_ror:2 row_mask:0xf bank_mask:0xf
    s_nop 0
    v_add_f32_dpp v41, v41, v41 row_ror:2 row_mask:0xf bank_mask:0xf
    v_add_f32_dpp v40, v40, v40 row_ror:4 row_mask:0xf bank_mask:0xf
    s_nop 0
    v_add_f32_dpp v41, v41, v41 row_ror:4 row_mask:0xf bank_mask:0xf
    v_add_f32_dpp v40, v40, v40 row_ror:8 row_mask:0xf bank_mask:0xf
    s_nop 0
    v_add_f32_dpp v41, v41, v41 row_ror:8 row_mask:0xf bank_mask:0xf
    v_mov_b32 v42, v40
    v_mov_b32 v43, v41
    s_nop 0
    v_permlane16_swap_b32 v40, v42
    v_permlane16_swap_b32 v41, v43
    v_add_f32 v40, v40, v42
    v_add_f32 v41, v41, v43
    v_mov_b32 v42, v40
    v_mov_b32 v43, v41
    s_nop 0
    v_permlane32_swap_b32 v40, v42
    v_permlane32_swap_b32 v41, v43
    v_add_f32 v40, v40, v42
    v_add_f32 v41, v41, v43
    v_mul_f32 v40, 0x3b000000, v40
    v_mul_f32 v41, 0x3b000000, v41
    v_sub_f32 v24, v24, v40
    v_sub_f32 v25, v25, v40
    v_sub_f32 v26, v26, v40
    v_sub_f32 v27, v27, v40
    v_sub_f32 v28, v28, v40
    v_sub_f32 v29, v29, v40
    v_sub_f32 v30, v30, v40
    v_sub_f32 v31, v31, v40
    v_mul_f32 v46, v24, v24
    v_fmac_f32 v46, v25, v25
    v_fmac_f32 v46, v26, v26
    v_fmac_f32 v46, v27, v27
    v_fmac_f32 v46, v28, v28
    v_fmac_f32 v46, v29, v29
    v_fmac_f32 v46, v30, v30
    v_fmac_f32 v46, v31, v31
    v_sub_f32 v32, v32, v41
    v_sub_f32 v33, v33, v41
    v_sub_f32 v34, v34, v41
    v_sub_f32 v35, v35, v41
    v_sub_f32 v36, v36, v41
    v_sub_f32 v37, v37, v41
    v_sub_f32 v38, v38, v41
    v_sub_f32 v39, v39, v41
    v_mul_f32 v47, v32, v32
    v_fmac_f32 v47, v33, v33
    v_fmac_f32 v47, v34, v34
    v_fmac_f32 v47, v35, v35
    v_fmac_f32 v47, v36, v36
    v_fmac_f32 v47, v37, v37
    v_fmac_f32 v47, v38, v38
    v_fmac_f32 v47, v39, v39
    v_add_f32_dpp v46, v46, v46 row_ror:1 row_mask:0xf bank_mask:0xf
    s_nop 0
    v_add_f32_dpp v47, v47, v47 row_ror:1 row_mask:0xf bank_mask:0xf
    v_add_f32_dpp v46, v46, v46 row_ror:2 row_mask:0xf bank_mask:0xf
    s_nop 0
    v_add_f32_dpp v47, v47, v47 row_ror:2 row_mask:0xf bank_mask:0xf
    v_add_f32_dpp v46, v46, v46 row_ror:4 row_mask:0xf bank_mask:0xf
    s_nop 0
    v_add_f32_dpp v47, v47, v47 row_ror:4 row_mask:0xf bank_mask:0xf
    v_add_f32_dpp v46, v46, v46 row_ror:8 row_mask:0xf bank_mask:0xf
    s_nop 0
    v_add_f32_dpp v47, v47, v47 row_ror:8 row_mask:0xf bank_mask:0xf
    v_mov_b32 v42, v46
    v_mov_b32 v43, v47
    s_nop 0
    v_permlane16_swap_b32 v46, v42
    v_permlane16_swap_b32 v47, v43
    v_add_f32 v46, v46, v42
    v_add_f32 v47, v47, v43
    v_mov_b32 v42, v46
    v_mov_b32 v43, v47
    s_nop 0
    v_permlane32_swap_b32 v46, v42
    v_permlane32_swap_b32 v47, v43
    v_add_f32 v46, v46, v42
    v_add_f32 v47, v47, v43
    v_mul_f32 v46, 0x3b000000, v46
    v_cvt_pk_bf16_f32 v46, v46, v46
    v_and_b32 v46, 0xffff0000, v46
    v_add_f32 v46, 0x3727c5ac, v46
    v_cvt_pk_bf16_f32 v46, v46, v46
    v_and_b32 v46, 0xffff0000, v46
    v_sqrt_f32 v46, v46
    s_nop 0
    v_cvt_pk_bf16_f32 v46, v46, v46
    v_and_b32 v46, 0xffff0000, v46
    v_rcp_f32 v46, v46
    v_cvt_pk_bf16_f32 v40, v40, v40
    v_and_b32 v40, 0xffff0000, v40
    v_mul_f32 v47, 0x3b000000, v47
    v_cvt_pk_bf16_f32 v47, v47, v47
    v_and_b32 v47, 0xffff0000, v47
    v_add_f32 v47, 0x3727c5ac, v47
    v_cvt_pk_bf16_f32 v47, v47, v47
    v_and_b32 v47, 0xffff0000, v47
    v_sqrt_f32 v47, v47
    s_nop 0
    v_cvt_pk_bf16_f32 v47, v47, v47
    v_and_b32 v47, 0xffff0000, v47
    v_rcp_f32 v47, v47
    v_cvt_pk_bf16_f32 v41, v41, v41
    v_and_b32 v41, 0xffff0000, v41
    v_and_b32 v4, 16, v0
    v_cmp_ne_u32 vcc, 0, v4
    s_nop 1
    v_cndmask_b32 v40, v40, v41, vcc
    v_cndmask_b32 v46, v46, v47, vcc
    v_lshlrev_b32 v24, 16, v16
    v_and_b32 v25, 0xffff0000, v16
    v_lshlrev_b32 v26, 16, v17
    v_and_b32 v27, 0xffff0000, v17
    v_sub_f32 v24, v24, v40
    v_sub_f32 v25, v25, v40
    v_sub_f32 v26, v26, v40
    v_sub_f32 v27, v27, v40
    v_cvt_pk_bf16_f32 v24, v24, v24
    v_cvt_pk_bf16_f32 v25, v25, v25
    v_cvt_pk_bf16_f32 v26, v26, v26
    v_cvt_pk_bf16_f32 v27, v27, v27
    v_and_b32 v24, 0xffff0000, v24
    v_and_b32 v25, 0xffff0000, v25
    v_and_b32 v26, 0xffff0000, v26
    v_and_b32 v27, 0xffff0000, v27
    v_mul_f32 v24, v24, v46
    v_mul_f32 v25, v25, v46
    v_mul_f32 v26, v26, v46
    v_mul_f32 v27, v27, v46
    v_cvt_pk_bf16_f32 v24, v24, v24
    v_cvt_pk_bf16_f32 v25, v25, v25
    v_cvt_pk_bf16_f32 v26, v26, v26
    v_cvt_pk_bf16_f32 v27, v27, v27
    v_and_b32 v24, 0xffff0000, v24
    v_and_b32 v25, 0xffff0000, v25
    v_and_b32 v26, 0xffff0000, v26
    v_and_b32 v27, 0xffff0000, v27
    v_lshrrev_b32 v4, 5, v0
    v_lshlrev_b32 v4, 14, v4
    v_and_b32 v6, 31, v0
    v_lshlrev_b32 v6, 4, v6
    v_add_u32 v4, v4, v6
    s_lshl_b32 s79, s7, 11
    s_add_u32 s79, s79, 32768
    v_bfe_u32 v5, v0, 4, 1
    v_mul_u32_u24 v5, 144, v5
    v_and_b32 v7, 15, v0
    v_lshlrev_b32 v7, 3, v7
    v_add_u32 v20, v5, v7
    v_add_u32 v20, 138240, v20
    v_and_b32 v5, 1, v0
    v_mul_u32_u24 v5, 144, v5
    v_lshrrev_b32 v6, 4, v0
    v_lshlrev_b32 v6, 4, v6
    v_add_u32 v21, v5, v6
    v_add_u32 v21, 138240, v21
    v_lshrrev_b32 v5, 4, v0
    v_bfe_u32 v6, v0, 2, 2
    v_mul_u32_u24 v7, 8, v5
    v_add_u32 v7, v7, v6
    v_lshlrev_b32 v7, 8, v7
    v_and_b32 v5, 1, v5
    v_lshlrev_b32 v5, 2, v5
    v_or_b32 v5, v5, v6
    v_lshlrev_b32 v5, 5, v5
    v_and_b32 v6, 1, v0
    v_lshlrev_b32 v6, 3, v6
    v_add_u32 v7, v7, v6
    v_bfe_u32 v6, v0, 1, 1
    v_lshlrev_b32 v6, 4, v6
    v_add_u32 v7, v7, v6
    v_add_u32 v7, 0, v7
    v_xor_b32 v22, 0, v5
    v_add_u32 v80, v7, v22
    v_xor_b32 v22, 32, v5
    v_add_u32 v81, v7, v22
    v_xor_b32 v22, 64, v5
    v_add_u32 v82, v7, v22
    v_xor_b32 v22, 96, v5
    v_add_u32 v83, v7, v22
    v_xor_b32 v22, 128, v5
    v_add_u32 v84, v7, v22
    v_xor_b32 v22, 160, v5
    v_add_u32 v85, v7, v22
    v_xor_b32 v22, 192, v5
    v_add_u32 v86, v7, v22
    v_xor_b32 v22, 224, v5
    v_add_u32 v87, v7, v22
    s_bfe_u32 s10, s43, 0x80000
    v_mov_b32 v88, s10
    s_bfe_u32 s10, s43, 0x80008
    v_mov_b32 v89, s10
    s_bfe_u32 s10, s43, 0x80010
    v_mov_b32 v90, s10
    s_bfe_u32 s10, s43, 0x80018
    v_mov_b32 v91, s10
    s_waitcnt vmcnt(0)
    s_mov_b32 s80, 0xff
    s_mov_b32 s81, 0
    v_and_b32 v7, 7, v0
    v_lshlrev_b32 v7, 4, v7
    s_mov_b64 s[62:63], -1
    s_mov_b64 s[64:65], -1
    s_mov_b64 s[66:67], -1
    s_mov_b64 s[68:69], -1
    s_mov_b64 s[82:83], s[80:81]
    s_mov_b32 s15, 65536
    s_sleep 8
L_mpoll_5:
    s_mov_b64 exec, s[62:63]
    buffer_load_dwordx4 v[32:35], v4, s[52:55], s79 offen sc1
    s_mov_b64 exec, s[64:65]
    s_add_u32 s13, s79, 512
    buffer_load_dwordx4 v[36:39], v4, s[52:55], s13 offen sc1
    s_mov_b64 exec, s[66:67]
    s_add_u32 s13, s79, 1024
    buffer_load_dwordx4 v[40:43], v4, s[52:55], s13 offen sc1
    s_mov_b64 exec, s[68:69]
    s_add_u32 s13, s79, 1536
    buffer_load_dwordx4 v[44:47], v4, s[52:55], s13 offen sc1
    s_mov_b64 exec, s[82:83]
    buffer_load_dwordx4 v[92:95], v7, s[52:55], s70 offen sc1
    s_mov_b64 exec, -1
    s_waitcnt vmcnt(0)
    v_perm_b32 v5, v33, v32, s73
    v_perm_b32 v6, v35, v34, s74
    v_or_b32 v5, v5, v6
    v_cmp_ne_u32 s[62:63], s43, v5
    v_perm_b32 v5, v37, v36, s73
    v_perm_b32 v6, v39, v38, s74
    v_or_b32 v5, v5, v6
    v_cmp_ne_u32 s[64:65], s43, v5
    v_perm_b32 v5, v41, v40, s73
    v_perm_b32 v6, v43, v42, s74
    v_or_b32 v5, v5, v6
    v_cmp_ne_u32 s[66:67], s43, v5
    v_perm_b32 v5, v45, v44, s73
    v_perm_b32 v6, v47, v46, s74
    v_or_b32 v5, v5, v6
    v_cmp_ne_u32 s[68:69], s43, v5
    v_perm_b32 v5, v93, v92, s73
    v_perm_b32 v6, v95, v94, s74
    v_or_b32 v5, v5, v6
    v_cmp_ne_u32 s[82:83], s43, v5
    s_nop 0
    s_and_b64 s[82:83], s[82:83], s[80:81]
    s_mov_b64 s[10:11], s[62:63]
    s_or_b64 s[10:11], s[10:11], s[64:65]
    s_or_b64 s[10:11], s[10:11], s[66:67]
    s_or_b64 s[10:11], s[10:11], s[68:69]
    s_or_b64 s[10:11], s[10:11], s[82:83]
    s_cmp_eq_u64 s[10:11], 0
    s_cbranch_scc1 L_mpolld_6
    s_sub_u32 s15, s15, 1
    s_cmp_eq_u32 s15, 0
    s_cbranch_scc1 L_abort
    s_sleep 1
    s_branch L_mpoll_5
L_mpolld_6:
    v_lshrrev_b32 v92, 8, v92
    v_cmp_ne_u32 vcc, s71, v92
    s_nop 0
    s_and_b64 s[10:11], vcc, s[80:81]
    s_cmp_eq_u64 s[10:11], 0
    s_cselect_b32 s71, 1, 2
    v_mov_b32 v5, s71
    s_mov_b64 exec, 1
    ds_write_b32 v3, v5 offset:44
    s_mov_b64 exec, -1
    v_and_b32 v32, s76, v32
    v_and_b32 v33, s76, v33
    v_and_b32 v34, s76, v34
    v_and_b32 v35, s76, v35
    v_and_b32 v36, s76, v36
    v_and_b32 v37, s76, v37
    v_and_b32 v38, s76, v38
    v_and_b32 v39, s76, v39
    v_and_b32 v40, s76, v40
    v_and_b32 v41, s76, v41
    v_and_b32 v42, s76, v42
    v_and_b32 v43, s76, v43
    v_and_b32 v44, s76, v44
    v_and_b32 v45, s76, v45
    v_and_b32 v46, s76, v46
    v_and_b32 v47, s76, v47
    v_add_f32 v32, v32, v36
    v_add_f32 v33, v33, v37
    v_add_f32 v34, v34, v38
    v_add_f32 v35, v35, v39
    v_add_f32 v40, v40, v44
    v_add_f32 v41, v41, v45
    v_add_f32 v42, v42, v46
    v_add_f32 v43, v43, v47
    v_add_f32 v32, v32, v40
    v_add_f32 v33, v33, v41
    v_add_f32 v34, v34, v42
    v_add_f32 v35, v35, v43
    v_cvt_pk_bf16_f32 v32, v32, v32
    v_cvt_pk_bf16_f32 v33, v33, v33
    v_cvt_pk_bf16_f32 v34, v34, v34
    v_cvt_pk_bf16_f32 v35, v35, v35
    v_and_b32 v32, 0xffff0000, v32
    v_and_b32 v33, 0xffff0000, v33
    v_and_b32 v34, 0xffff0000, v34
    v_and_b32 v35, 0xffff0000, v35
    v_mov_b32 v36, v32
    v_mov_b32 v37, v33
    v_mov_b32 v38, v34
    v_mov_b32 v39, v35
    v_permlane32_swap_b32 v32, v36
    v_permlane32_swap_b32 v33, v37
    v_permlane32_swap_b32 v34, v38
    v_permlane32_swap_b32 v35, v39
    v_add_f32 v36, 1.0, v36
    v_add_f32 v37, 1.0, v37
    v_add_f32 v38, 1.0, v38
    v_add_f32 v39, 1.0, v39
    v_cvt_pk_bf16_f32 v36, v36, v36
    v_cvt_pk_bf16_f32 v37, v37, v37
    v_cvt_pk_bf16_f32 v38, v38, v38
    v_cvt_pk_bf16_f32 v39, v39, v39
    v_and_b32 v36, 0xffff0000, v36
    v_and_b32 v37, 0xffff0000, v37
    v_and_b32 v38, 0xffff0000, v38
    v_and_b32 v39, 0xffff0000, v39
    v_mul_f32 v24, v24, v36
    v_mul_f32 v25, v25, v37
    v_mul_f32 v26, v26, v38
    v_mul_f32 v27, v27, v39
    v_cvt_pk_bf16_f32 v24, v24, v24
    v_cvt_pk_bf16_f32 v25, v25, v25
    v_cvt_pk_bf16_f32 v26, v26, v26
    v_cvt_pk_bf16_f32 v27, v27, v27
    v_and_b32 v24, 0xffff0000, v24
    v_and_b32 v25, 0xffff0000, v25
    v_and_b32 v26, 0xffff0000, v26
    v_and_b32 v27, 0xffff0000, v27
    v_add_f32 v24, v24, v32
    v_add_f32 v25, v25, v33
    v_add_f32 v26, v26, v34
    v_add_f32 v27, v27, v35
    v_cvt_pk_bf16_f32 v24, v24, v25
    v_cvt_pk_bf16_f32 v25, v26, v27
    s_mov_b32 exec_hi, 0
    ds_write_b64 v20, v[24:25]
    s_mov_b64 exec, -1
    ds_read_b128 v[32:35], v21
    ds_read_b128 v[36:39], v21 offset:64
    ds_read_b64_tr_b16 v[96:97], v80 offset:0
    ds_read_b64_tr_b16 v[98:99], v80 offset:1024
    ds_read_b64_tr_b16 v[100:101], v81 offset:0
    ds_read_b64_tr_b16 v[102:103], v81 offset:1024
    ds_read_b64_tr_b16 v[104:105], v82 offset:0
    ds_read_b64_tr_b16 v[106:107], v82 offset:1024
    ds_read_b64_tr_b16 v[108:109], v83 offset:0
    ds_read_b64_tr_b16 v[110:111], v83 offset:1024
    s_waitcnt lgkmcnt(6)
    v_mfma_f32_16x16x32_bf16 v[48:51], v[96:99], v[32:35], 0
    s_waitcnt lgkmcnt(4)
    v_mfma_f32_16x16x32_bf16 v[52:55], v[100:103], v[32:35], 0
    s_waitcnt lgkmcnt(2)
    v_mfma_f32_16x16x32_bf16 v[56:59], v[104:107], v[32:35], 0
    s_waitcnt lgkmcnt(0)
    v_mfma_f32_16x16x32_bf16 v[60:63], v[108:111], v[32:35], 0
    ds_read_b64_tr_b16 v[112:113], v84 offset:0
    ds_read_b64_tr_b16 v[114:115], v84 offset:1024
    ds_read_b64_tr_b16 v[116:117], v85 offset:0
    ds_read_b64_tr_b16 v[118:119], v85 offset:1024
    ds_read_b64_tr_b16 v[120:121], v86 offset:0
    ds_read_b64_tr_b16 v[122:123], v86 offset:1024
    ds_read_b64_tr_b16 v[124:125], v87 offset:0
    ds_read_b64_tr_b16 v[126:127], v87 offset:1024
    s_waitcnt lgkmcnt(6)
    v_mfma_f32_16x16x32_bf16 v[64:67], v[112:115], v[32:35], 0
    s_waitcnt lgkmcnt(4)
    v_mfma_f32_16x16x32_bf16 v[68:71], v[116:119], v[32:35], 0
    s_waitcnt lgkmcnt(2)
    v_mfma_f32_16x16x32_bf16 v[72:75], v[120:123], v[32:35], 0
    s_waitcnt lgkmcnt(0)
    v_mfma_f32_16x16x32_bf16 v[76:79], v[124:127], v[32:35], 0
    ds_read_b64_tr_b16 v[96:97], v80 offset:8192
    ds_read_b64_tr_b16 v[98:99], v80 offset:9216
    ds_read_b64_tr_b16 v[100:101], v81 offset:8192
    ds_read_b64_tr_b16 v[102:103], v81 offset:9216
    ds_read_b64_tr_b16 v[104:105], v82 offset:8192
    ds_read_b64_tr_b16 v[106:107], v82 offset:9216
    ds_read_b64_tr_b16 v[108:109], v83 offset:8192
    ds_read_b64_tr_b16 v[110:111], v83 offset:9216
    s_waitcnt lgkmcnt(6)
    v_mfma_f32_16x16x32_bf16 v[48:51], v[96:99], v[36:39], v[48:51]
    s_waitcnt lgkmcnt(4)
    v_mfma_f32_16x16x32_bf16 v[52:55], v[100:103], v[36:39], v[52:55]
    s_waitcnt lgkmcnt(2)
    v_mfma_f32_16x16x32_bf16 v[56:59], v[104:107], v[36:39], v[56:59]
    s_waitcnt lgkmcnt(0)
    v_mfma_f32_16x16x32_bf16 v[60:63], v[108:111], v[36:39], v[60:63]
    ds_read_b64_tr_b16 v[112:113], v84 offset:8192
    ds_read_b64_tr_b16 v[114:115], v84 offset:9216
    ds_read_b64_tr_b16 v[116:117], v85 offset:8192
    ds_read_b64_tr_b16 v[118:119], v85 offset:9216
    ds_read_b64_tr_b16 v[120:121], v86 offset:8192
    ds_read_b64_tr_b16 v[122:123], v86 offset:9216
    ds_read_b64_tr_b16 v[124:125], v87 offset:8192
    ds_read_b64_tr_b16 v[126:127], v87 offset:9216
    s_waitcnt lgkmcnt(6)
    v_mfma_f32_16x16x32_bf16 v[64:67], v[112:115], v[36:39], v[64:67]
    s_waitcnt lgkmcnt(4)
    v_mfma_f32_16x16x32_bf16 v[68:71], v[116:119], v[36:39], v[68:71]
    s_waitcnt lgkmcnt(2)
    v_mfma_f32_16x16x32_bf16 v[72:75], v[120:123], v[36:39], v[72:75]
    s_waitcnt lgkmcnt(0)
    v_mfma_f32_16x16x32_bf16 v[76:79], v[124:127], v[36:39], v[76:79]
    v_and_b32 v4, 1, v0
    v_lshlrev_b32 v4, 9, v4
    v_bfe_u32 v5, v0, 1, 3
    v_lshlrev_b32 v5, 6, v5
    v_lshrrev_b32 v6, 4, v0
    v_lshlrev_b32 v6, 4, v6
    v_add3_u32 v4, v4, v5, v6
    s_lshl_b32 s12, s4, 3
    s_add_u32 s12, s12, s7
    s_lshl_b32 s12, s12, 10
    s_add_u32 s12, s12, 131072
    s_mov_b32 s10, 0x000c000c
    s_mov_b32 s11, 0x000c000c
    v_cndmask_b32_e64 v24, v48, v52, s[10:11]
    v_cndmask_b32_e64 v25, v49, v53, s[10:11]
    v_cndmask_b32_e64 v26, v50, v54, s[10:11]
    v_cndmask_b32_e64 v27, v51, v55, s[10:11]
    s_lshl_b64 s[10:11], s[10:11], 2
    v_cndmask_b32_e64 v24, v24, v56, s[10:11]
    v_cndmask_b32_e64 v25, v25, v57, s[10:11]
    v_cndmask_b32_e64 v26, v26, v58, s[10:11]
    v_cndmask_b32_e64 v27, v27, v59, s[10:11]
    s_lshl_b64 s[10:11], s[10:11], 2
    v_cndmask_b32_e64 v24, v24, v60, s[10:11]
    v_cndmask_b32_e64 v25, v25, v61, s[10:11]
    v_cndmask_b32_e64 v26, v26, v62, s[10:11]
    v_cndmask_b32_e64 v27, v27, v63, s[10:11]
    s_lshl_b64 s[10:11], s[10:11], 2
    v_cndmask_b32_e64 v24, v24, v64, s[10:11]
    v_cndmask_b32_e64 v25, v25, v65, s[10:11]
    v_cndmask_b32_e64 v26, v26, v66, s[10:11]
    v_cndmask_b32_e64 v27, v27, v67, s[10:11]
    s_lshl_b64 s[10:11], s[10:11], 2
    v_cndmask_b32_e64 v24, v24, v68, s[10:11]
    v_cndmask_b32_e64 v25, v25, v69, s[10:11]
    v_cndmask_b32_e64 v26, v26, v70, s[10:11]
    v_cndmask_b32_e64 v27, v27, v71, s[10:11]
    s_lshl_b64 s[10:11], s[10:11], 2
    v_cndmask_b32_e64 v24, v24, v72, s[10:11]
    v_cndmask_b32_e64 v25, v25, v73, s[10:11]
    v_cndmask_b32_e64 v26, v26, v74, s[10:11]
    v_cndmask_b32_e64 v27, v27, v75, s[10:11]
    s_lshl_b64 s[10:11], s[10:11], 2
    v_cndmask_b32_e64 v24, v24, v76, s[10:11]
    v_cndmask_b32_e64 v25, v25, v77, s[10:11]
    v_cndmask_b32_e64 v26, v26, v78, s[10:11]
    v_cndmask_b32_e64 v27, v27, v79, s[10:11]
    v_bfi_b32 v24, s76, v24, v88
    v_bfi_b32 v25, s76, v25, v89
    v_bfi_b32 v26, s76, v26, v90
    v_bfi_b32 v27, s76, v27, v91
    s_cmp_eq_u32 s71, 1
    s_cbranch_scc0 L_stw_7
    buffer_store_dwordx4 v[24:27], v4, s[52:55], s12 offen
    s_branch L_std_8
L_stw_7:
    buffer_store_dwordx4 v[24:27], v4, s[52:55], s12 offen sc1
L_std_8:
    v_lshrrev_b32 v4, 5, v0
    v_lshlrev_b32 v4, 10, v4
    v_and_b32 v5, 31, v0
    v_lshlrev_b32 v5, 4, v5
    v_add_u32 v4, v4, v5
    s_lshl_b32 s79, s4, 13
    s_lshl_b32 s11, s5, 9
    s_add_u32 s79, s79, s11
    s_add_u32 s79, s79, 131072
    v_lshlrev_b32 v20, 3, v0
    v_add_u32 v20, 131328, v20
    s_mov_b64 s[62:63], -1
    s_mov_b64 s[64:65], -1
    s_mov_b64 s[66:67], -1
    s_mov_b64 s[68:69], -1
    s_mov_b32 s15, 65536
    s_sleep 8
L_mpoll_9:
    s_mov_b64 exec, s[62:63]
    buffer_load_dwordx4 v[32:35], v4, s[52:55], s79 offen sc1
    s_mov_b64 exec, s[64:65]
    s_add_u32 s13, s79, 2048
    buffer_load_dwordx4 v[36:39], v4, s[52:55], s13 offen sc1
    s_mov_b64 exec, s[66:67]
    s_add_u32 s13, s79, 4096
    buffer_load_dwordx4 v[40:43], v4, s[52:55], s13 offen sc1
    s_mov_b64 exec, s[68:69]
    s_add_u32 s13, s79, 6144
    buffer_load_dwordx4 v[44:47], v4, s[52:55], s13 offen sc1
    s_mov_b64 exec, -1
    s_waitcnt vmcnt(0)
    v_perm_b32 v5, v33, v32, s73
    v_perm_b32 v6, v35, v34, s74
    v_or_b32 v5, v5, v6
    v_cmp_ne_u32 s[62:63], s43, v5
    v_perm_b32 v5, v37, v36, s73
    v_perm_b32 v6, v39, v38, s74
    v_or_b32 v5, v5, v6
    v_cmp_ne_u32 s[64:65], s43, v5
    v_perm_b32 v5, v41, v40, s73
    v_perm_b32 v6, v43, v42, s74
    v_or_b32 v5, v5, v6
    v_cmp_ne_u32 s[66:67], s43, v5
    v_perm_b32 v5, v45, v44, s73
    v_perm_b32 v6, v47, v46, s74
    v_or_b32 v5, v5, v6
    v_cmp_ne_u32 s[68:69], s43, v5
    s_mov_b64 s[10:11], s[62:63]
    s_or_b64 s[10:11], s[10:11], s[64:65]
    s_or_b64 s[10:11], s[10:11], s[66:67]
    s_or_b64 s[10:11], s[10:11], s[68:69]
    s_cmp_eq_u64 s[10:11], 0
    s_cbranch_scc1 L_mpolld_10
    s_sub_u32 s15, s15, 1
    s_cmp_eq_u32 s15, 0
    s_cbranch_scc1 L_abort
    s_sleep 1
    s_branch L_mpoll_9
L_mpolld_10:
    v_and_b32 v32, s76, v32
    v_and_b32 v33, s76, v33
    v_and_b32 v34, s76, v34
    v_and_b32 v35, s76, v35
    v_and_b32 v36, s76, v36
    v_and_b32 v37, s76, v37
    v_and_b32 v38, s76, v38
    v_and_b32 v39, s76, v39
    v_and_b32 v40, s76, v40
    v_and_b32 v41, s76, v41
    v_and_b32 v42, s76, v42
    v_and_b32 v43, s76, v43
    v_and_b32 v44, s76, v44
    v_and_b32 v45, s76, v45
    v_and_b32 v46, s76, v46
    v_and_b32 v47, s76, v47
    v_add_f32 v32, v32, v36
    v_add_f32 v33, v33, v37
    v_add_f32 v34, v34, v38
    v_add_f32 v35, v35, v39
    v_add_f32 v40, v40, v44
    v_add_f32 v41, v41, v45
    v_add_f32 v42, v42, v46
    v_add_f32 v43, v43, v47
    v_add_f32 v32, v32, v40
    v_add_f32 v33, v33, v41
    v_add_f32 v34, v34, v42
    v_add_f32 v35, v35, v43
    v_mov_b32 v36, v32
    v_mov_b32 v37, v33
    v_mov_b32 v38, v34
    v_mov_b32 v39, v35
    v_permlane32_swap_b32 v32, v36
    v_permlane32_swap_b32 v33, v37
    v_permlane32_swap_b32 v34, v38
    v_permlane32_swap_b32 v35, v39
    v_add_f32 v32, v32, v36
    v_add_f32 v33, v33, v37
    v_add_f32 v34, v34, v38
    v_add_f32 v35, v35, v39
    v_cvt_pk_bf16_f32 v32, v32, v33
    v_cvt_pk_bf16_f32 v33, v34, v35
    s_mov_b32 exec_hi, 0
    ds_write_b64 v20, v[32:33]
    s_mov_b64 exec, -1
    v_mov_b32 v4, 1
    s_mov_b64 exec, 1
    ds_write_b32 v3, v4 offset:0
    s_mov_b64 exec, -1
    s_branch L_tail
L_h2:
    s_waitcnt lgkmcnt(0)
    s_mul_i32 s43, s42, 1664525
    s_add_u32 s43, s43, 1013904223
    s_mov_b32 s72, 0x05040100
    s_mov_b32 s73, 0x0c0c0400
    s_mov_b32 s74, 0x04000c0c
    s_mov_b32 s75, 0xffff0000
    s_mov_b32 s76, 0xffffff00
    s_and_b32 s77, s43, 0xffff
    s_lshr_b32 s78, s43, 16
    s_cmp_eq_u32 s59, 0
    s_cbranch_scc1 L_tail
    s_mov_b32 s44, s24
    s_and_b32 s45, s25, 0xffff
    s_mov_b32 s46, 0x400000
    s_mov_b32 s47, 0x20000
    v_lshrrev_b32 v4, 4, v0
    v_lshlrev_b32 v5, 10, v4
    v_lshlrev_b32 v4, 5, v4
    v_and_b32 v6, 15, v0
    v_lshlrev_b32 v6, 4, v6
    v_xor_b32 v6, v6, v4
    v_add_u32 v8, v5, v6
    v_xor_b32 v6, 0x80, v6
    v_add_u32 v9, v5, v6
    s_lshl_b32 s12, s4, 17
    s_lshl_b32 s10, s56, 8
    s_add_u32 s12, s12, s10
    s_mov_b32 s15, 65536
L_lw_11:
    ds_read_b32 v4, v3 offset:0
    s_waitcnt lgkmcnt(0)
    v_readfirstlane_b32 s14, v4
    s_nop 0
    s_cmp_lg_u32 s14, 0
    s_cbranch_scc1 L_lwd_12
    s_sub_u32 s15, s15, 1
    s_cmp_eq_u32 s15, 0
    s_cbranch_scc1 L_abort
    s_sleep 4
    s_branch L_lw_11
L_lwd_12:
    s_mov_b32 s15, 65536
L_lw_13:
    ds_read_b32 v4, v3 offset:32
    s_waitcnt lgkmcnt(0)
    v_readfirstlane_b32 s14, v4
    s_nop 0
    s_cmp_lg_u32 s14, 0
    s_cbranch_scc1 L_lwd_14
    s_sub_u32 s15, s15, 1
    s_cmp_eq_u32 s15, 0
    s_cbranch_scc1 L_abort
    s_sleep 4
    s_branch L_lw_13
L_lwd_14:
    s_mov_b32 s15, 65536
L_lw_15:
    ds_read_b32 v4, v3 offset:40
    s_waitcnt lgkmcnt(0)
    v_readfirstlane_b32 s14, v4
    s_nop 0
    s_cmp_eq_u32 s14, 8
    s_cbranch_scc1 L_lwd_16
    s_sub_u32 s15, s15, 1
    s_cmp_eq_u32 s15, 0
    s_cbranch_scc1 L_abort
    s_sleep 2
    s_branch L_lw_15
L_lwd_16:
    s_mov_b32 m0, 0
    s_add_u32 s11, s12, 0
    buffer_load_dwordx4 v8, s[44:47], s11 offen nt lds
    s_mov_b32 m0, 1024
    s_add_u32 s11, s12, 4096
    buffer_load_dwordx4 v8, s[44:47], s11 offen nt lds
    s_mov_b32 m0, 2048
    s_add_u32 s11, s12, 8192
    buffer_load_dwordx4 v9, s[44:47], s11 offen nt lds
    s_mov_b32 m0, 3072
    s_add_u32 s11, s12, 12288
    buffer_load_dwordx4 v9, s[44:47], s11 offen nt lds
    s_mov_b32 m0, 4096
    s_add_u32 s11, s12, 16384
    buffer_load_dwordx4 v8, s[44:47], s11 offen nt lds
    s_mov_b32 m0, 5120
    s_add_u32 s11, s12, 20480
    buffer_load_dwordx4 v8, s[44:47], s11 offen nt lds
    s_mov_b32 m0, 6144
    s_add_u32 s11, s12, 24576
    buffer_load_dwordx4 v9, s[44:47], s11 offen nt lds
    s_mov_b32 m0, 7168
    s_add_u32 s11, s12, 28672
    buffer_load_dwordx4 v9, s[44:47], s11 offen nt lds
    s_mov_b32 m0, 8192
    s_add_u32 s11, s12, 32768
    buffer_load_dwordx4 v8, s[44:47], s11 offen nt lds
    s_mov_b32 m0, 9216
    s_add_u32 s11, s12, 36864
    buffer_load_dwordx4 v8, s[44:47], s11 offen nt lds
    s_mov_b32 m0, 10240
    s_add_u32 s11, s12, 40960
    buffer_load_dwordx4 v9, s[44:47], s11 offen nt lds
    s_mov_b32 m0, 11264
    s_add_u32 s11, s12, 45056
    buffer_load_dwordx4 v9, s[44:47], s11 offen nt lds
    s_mov_b32 m0, 12288
    s_add_u32 s11, s12, 49152
    buffer_load_dwordx4 v8, s[44:47], s11 offen nt lds
    s_mov_b32 m0, 13312
    s_add_u32 s11, s12, 53248
    buffer_load_dwordx4 v8, s[44:47], s11 offen nt lds
    s_mov_b32 m0, 14336
    s_add_u32 s11, s12, 57344
    buffer_load_dwordx4 v9, s[44:47], s11 offen nt lds
    s_mov_b32 m0, 15360
    s_add_u32 s11, s12, 61440
    buffer_load_dwordx4 v9, s[44:47], s11 offen nt lds
    s_mov_b32 m0, 16384
    s_add_u32 s11, s12, 65536
    buffer_load_dwordx4 v8, s[44:47], s11 offen nt lds
    s_mov_b32 m0, 17408
    s_add_u32 s11, s12, 69632
    buffer_load_dwordx4 v8, s[44:47], s11 offen nt lds
    s_mov_b32 m0, 18432
    s_add_u32 s11, s12, 73728
    buffer_load_dwordx4 v9, s[44:47], s11 offen nt lds
    s_mov_b32 m0, 19456
    s_add_u32 s11, s12, 77824
    buffer_load_dwordx4 v9, s[44:47], s11 offen nt lds
    s_mov_b32 m0, 20480
    s_add_u32 s11, s12, 81920
    buffer_load_dwordx4 v8, s[44:47], s11 offen nt lds
    s_mov_b32 m0, 21504
    s_add_u32 s11, s12, 86016
    buffer_load_dwordx4 v8, s[44:47], s11 offen nt lds
    s_mov_b32 m0, 22528
    s_add_u32 s11, s12, 90112
    buffer_load_dwordx4 v9, s[44:47], s11 offen nt lds
    s_mov_b32 m0, 23552
    s_add_u32 s11, s12, 94208
    buffer_load_dwordx4 v9, s[44:47], s11 offen nt lds
    s_mov_b32 m0, 24576
    s_add_u32 s11, s12, 98304
    buffer_load_dwordx4 v8, s[44:47], s11 offen nt lds
    s_mov_b32 m0, 25600
    s_add_u32 s11, s12, 102400
    buffer_load_dwordx4 v8, s[44:47], s11 offen nt lds
    s_mov_b32 m0, 26624
    s_add_u32 s11, s12, 106496
    buffer_load_dwordx4 v9, s[44:47], s11 offen nt lds
    s_mov_b32 m0, 27648
    s_add_u32 s11, s12, 110592
    buffer_load_dwordx4 v9, s[44:47], s11 offen nt lds
    s_mov_b32 m0, 28672
    s_add_u32 s11, s12, 114688
    buffer_load_dwordx4 v8, s[44:47], s11 offen nt lds
    s_mov_b32 m0, 29696
    s_add_u32 s11, s12, 118784
    buffer_load_dwordx4 v8, s[44:47], s11 offen nt lds
    s_mov_b32 m0, 30720
    s_add_u32 s11, s12, 122880
    buffer_load_dwordx4 v9, s[44:47], s11 offen nt lds
    s_mov_b32 m0, 31744
    s_add_u32 s11, s12, 126976
    buffer_load_dwordx4 v9, s[44:47], s11 offen nt lds
    s_waitcnt vmcnt(0)
    v_mov_b32 v4, 1
    s_mov_b64 exec, 1
    ds_write_b32 v3, v4 offset:4
    s_mov_b64 exec, -1
    s_branch L_tail
L_h3:
    s_getpc_b64 s[10:11]
L_pc:
    s_sub_u32 s10, s10, L_pc-adaLN_cond__gqa_block_cached__dense_activation_silu__decode_kernel
    s_subb_u32 s11, s11, 0
    v_lshlrev_b32 v4, 7, v0
    s_lshl_b32 s12, s8, 10
    v_add_u32 v4, s12, v4
    v_min_u32 v4, L_end-adaLN_cond__gqa_block_cached__dense_activation_silu__decode_kernel-4, v4
    s_mov_b64 exec, 0xff
    global_load_dword v8, v4, s[10:11]
    s_mov_b64 exec, -1
    s_waitcnt lgkmcnt(0)
    s_mul_i32 s43, s42, 1664525
    s_add_u32 s43, s43, 1013904223
    s_mov_b32 s72, 0x05040100
    s_mov_b32 s73, 0x0c0c0400
    s_mov_b32 s74, 0x04000c0c
    s_mov_b32 s75, 0xffff0000
    s_mov_b32 s76, 0xffffff00
    s_and_b32 s77, s43, 0xffff
    s_lshr_b32 s78, s43, 16
    s_waitcnt vmcnt(0)
    s_mov_b32 s15, 65536
L_lw_17:
    ds_read_b32 v4, v3 offset:8
    s_waitcnt lgkmcnt(0)
    v_readfirstlane_b32 s14, v4
    s_nop 0
    s_cmp_eq_u32 s14, 8
    s_cbranch_scc1 L_lwd_18
    s_sub_u32 s15, s15, 1
    s_cmp_eq_u32 s15, 0
    s_cbranch_scc1 L_abort
    s_sleep 4
    s_branch L_lw_17
L_lwd_18:
    v_and_b32 v4, 7, v0
    v_lshlrev_b32 v4, 3, v4
    v_add_u32 v4, 131584, v4
    ds_read_b64 v[8:9], v4
    s_waitcnt lgkmcnt(0)
    v_mov_b32 v10, v8
    s_nop 1
    v_max_f32_dpp v10, v10, v10 row_ror:1 row_mask:0xf bank_mask:0xf
    s_nop 1
    v_max_f32_dpp v10, v10, v10 row_ror:2 row_mask:0xf bank_mask:0xf
    s_nop 1
    v_max_f32_dpp v10, v10, v10 row_ror:4 row_mask:0xf bank_mask:0xf
    v_sub_f32 v11, v8, v10
    v_mul_f32 v11, 0x3fb8aa3b, v11
    v_exp_f32 v11, v11
    s_nop 0
    v_mul_f32 v11, v11, v9
    s_nop 1
    v_add_f32_dpp v11, v11, v11 row_ror:1 row_mask:0xf bank_mask:0xf
    s_nop 1
    v_add_f32_dpp v11, v11, v11 row_ror:2 row_mask:0xf bank_mask:0xf
    s_nop 1
    v_add_f32_dpp v11, v11, v11 row_ror:4 row_mask:0xf bank_mask:0xf
    v_mov_b32 v12, v10
    v_mov_b32 v13, v11
    v_mov_b32 v14, s43
    v_mov_b32 v15, s43
    s_lshl_b32 s12, s5, 5
    s_add_u32 s12, s12, s4
    s_lshl_b32 s12, s12, 7
    s_add_u32 s12, s12, 393216
    s_lshl_b32 s10, s6, 4
    v_mov_b32 v4, s10
    ds_read_b32 v5, v3 offset:44
    s_waitcnt lgkmcnt(0)
    v_readfirstlane_b32 s63, v5
    s_mov_b64 exec, 1
    s_cmp_eq_u32 s63, 1
    s_cbranch_scc0 L_stw_19
    buffer_store_dwordx4 v[12:15], v4, s[52:55], s12 offen
    s_branch L_std_20
L_stw_19:
    buffer_store_dwordx4 v[12:15], v4, s[52:55], s12 offen sc1
L_std_20:
    s_mov_b64 exec, -1
    v_and_b32 v4, 3, v0
    v_lshlrev_b32 v4, 4, v4
    s_mov_b32 s15, 65536
L_poll_21:
    buffer_load_dwordx4 v[16:19], v4, s[52:55], s12 offen sc1
    s_waitcnt vmcnt(0)
    v_cmp_ne_u32 s[10:11], s43, v18
    v_cmp_ne_u32 vcc, s43, v19
    s_nop 0
    s_or_b64 s[10:11], s[10:11], vcc
    s_cmp_eq_u64 s[10:11], 0
    s_cbranch_scc1 L_polld_22
    s_sub_u32 s15, s15, 1
    s_cmp_eq_u32 s15, 0
    s_cbranch_scc1 L_abort
    s_sleep 2
    s_branch L_poll_21
L_polld_22:
    v_mov_b32 v20, v16
    s_nop 1
    v_max_f32_dpp v20, v20, v20 row_ror:1 row_mask:0xf bank_mask:0xf
    s_nop 1
    v_max_f32_dpp v20, v20, v20 row_ror:2 row_mask:0xf bank_mask:0xf
    v_sub_f32 v21, v16, v20
    v_mul_f32 v21, 0x3fb8aa3b, v21
    v_exp_f32 v21, v21
    s_nop 0
    v_mul_f32 v21, v21, v17
    s_nop 1
    v_add_f32_dpp v21, v21, v21 row_ror:1 row_mask:0xf bank_mask:0xf
    s_nop 1
    v_add_f32_dpp v21, v21, v21 row_ror:2 row_mask:0xf bank_mask:0xf
    v_rcp_f32 v21, v21
    v_sub_f32 v22, v8, v20
    v_mul_f32 v22, 0x3fb8aa3b, v22
    v_exp_f32 v22, v22
    s_nop 0
    v_mul_f32 v22, v22, v21
    v_lshlrev_b32 v4, 2, v0
    v_add_u32 v4, 131712, v4
    s_mov_b64 exec, 0xff
    ds_write_b32 v4, v22
    s_mov_b64 exec, -1
    v_mov_b32 v4, 1
    s_mov_b64 exec, 1
    ds_write_b32 v3, v4 offset:12
    s_mov_b64 exec, -1
    s_branch L_tail
L_tail:
    s_cmp_lg_u32 s59, 0
    s_cbranch_scc1 L_wo
    s_bitcmp1_b32 s9, 0
    s_cbranch_scc1 L_tail_odd
    s_cmp_lt_u32 s58, 43
    s_cbranch_scc1 L_mlp
    s_branch L_hexit
L_tail_odd:
    s_cmp_lg_u32 s3, 0
    s_cbranch_scc1 L_hexit
    s_cmp_lt_u32 s58, 32
    s_cbranch_scc1 L_red
    s_branch L_fin
L_hexit:
    s_endpgm
L_wo:
    s_lshl_b32 s64, s3, 6
    v_lshrrev_b32 v4, 4, v0
    v_bfe_u32 v5, v0, 2, 2
    v_mul_u32_u24 v6, 8, v4
    v_add_u32 v6, v6, v5
    v_lshlrev_b32 v6, 8, v6
    v_and_b32 v4, 1, v4
    v_lshlrev_b32 v4, 2, v4
    v_or_b32 v4, v4, v5
    v_lshlrev_b32 v4, 5, v4
    v_and_b32 v5, 1, v0
    v_lshlrev_b32 v5, 3, v5
    v_add_u32 v6, v6, v5
    v_bfe_u32 v5, v0, 1, 1
    v_lshlrev_b32 v5, 4, v5
    v_add_u32 v6, v6, v5
    v_add_u32 v6, 0, v6
    s_add_u32 s10, s64, 0
    v_xor_b32 v7, s10, v4
    v_add_u32 v24, v6, v7
    s_add_u32 s10, s64, 32
    v_xor_b32 v7, s10, v4
    v_add_u32 v25, v6, v7
    v_and_b32 v4, 1, v0
    v_mul_u32_u24 v20, 272, v4
    v_lshrrev_b32 v5, 4, v0
    v_lshlrev_b32 v5, 4, v5
    v_add_u32 v20, v20, v5
    v_add_u32 v20, 137216, v20
    v_lshlrev_b32 v21, 16, v4
    v_bfe_u32 v4, v0, 1, 1
    v_lshlrev_b32 v4, 6, v4
    v_add3_u32 v21, v21, v4, v5
    s_lshl_b32 s65, s4, 11
    s_lshl_b32 s10, s56, 9
    s_add_u32 s65, s65, s10
    s_lshl_b32 s10, s3, 7
    s_add_u32 s65, s65, s10
    s_add_u32 s65, s65, 589824
    s_bfe_u32 s10, s43, 0x80000
    v_mov_b32 v28, s10
    s_bfe_u32 s10, s43, 0x80008
    v_mov_b32 v29, s10
    s_bfe_u32 s10, s43, 0x80010
    v_mov_b32 v30, s10
    s_bfe_u32 s10, s43, 0x80018
    v_mov_b32 v31, s10
    s_mov_b32 s15, 65536
L_lw_23:
    ds_read_b32 v4, v3 offset:4
    s_waitcnt lgkmcnt(0)
    v_readfirstlane_b32 s14, v4
    s_nop 0
    s_cmp_lg_u32 s14, 0
    s_cbranch_scc1 L_lwd_24
    s_sub_u32 s15, s15, 1
    s_cmp_eq_u32 s15, 0
    s_cbranch_scc1 L_abort
    s_sleep 4
    s_branch L_lw_23
L_lwd_24:
    ds_read_b64_tr_b16 v[64:65], v24 offset:0
    ds_read_b64_tr_b16 v[66:67], v24 offset:1024
    ds_read_b64_tr_b16 v[68:69], v25 offset:0
    ds_read_b64_tr_b16 v[70:71], v25 offset:1024
    ds_read_b64_tr_b16 v[72:73], v24 offset:8192
    ds_read_b64_tr_b16 v[74:75], v24 offset:9216
    ds_read_b64_tr_b16 v[76:77], v25 offset:8192
    ds_read_b64_tr_b16 v[78:79], v25 offset:9216
    s_waitcnt lgkmcnt(0)
    ds_read_b64_tr_b16 v[80:81], v24 offset:16384
    ds_read_b64_tr_b16 v[82:83], v24 offset:17408
    ds_read_b64_tr_b16 v[84:85], v25 offset:16384
    ds_read_b64_tr_b16 v[86:87], v25 offset:17408
    ds_read_b64_tr_b16 v[88:89], v24 offset:24576
    ds_read_b64_tr_b16 v[90:91], v24 offset:25600
    ds_read_b64_tr_b16 v[92:93], v25 offset:24576
    ds_read_b64_tr_b16 v[94:95], v25 offset:25600
    s_waitcnt lgkmcnt(0)
    s_barrier
    ds_read_b128 v[48:51], v20 offset:0
    ds_read_b128 v[52:55], v20 offset:64
    ds_read_b128 v[56:59], v20 offset:128
    ds_read_b128 v[60:63], v20 offset:192
    s_waitcnt lgkmcnt(3)
    v_mfma_f32_16x16x32_bf16 v[32:35], v[64:67], v[48:51], 0
    v_mfma_f32_16x16x32_bf16 v[36:39], v[68:71], v[48:51], 0
    s_waitcnt lgkmcnt(2)
    v_mfma_f32_16x16x32_bf16 v[32:35], v[72:75], v[52:55], v[32:35]
    v_mfma_f32_16x16x32_bf16 v[36:39], v[76:79], v[52:55], v[36:39]
    s_waitcnt lgkmcnt(1)
    v_mfma_f32_16x16x32_bf16 v[32:35], v[80:83], v[56:59], v[32:35]
    v_mfma_f32_16x16x32_bf16 v[36:39], v[84:87], v[56:59], v[36:39]
    s_waitcnt lgkmcnt(0)
    v_mfma_f32_16x16x32_bf16 v[32:35], v[88:91], v[60:63], v[32:35]
    v_mfma_f32_16x16x32_bf16 v[36:39], v[92:95], v[60:63], v[36:39]
    s_mov_b32 s10, 0x000c000c
    s_mov_b32 s11, 0x000c000c
    s_nop 5
    v_cndmask_b32_e64 v32, v32, v36, s[10:11]
    v_cndmask_b32_e64 v33, v33, v37, s[10:11]
    v_cndmask_b32_e64 v34, v34, v38, s[10:11]
    v_cndmask_b32_e64 v35, v35, v39, s[10:11]
    v_bfi_b32 v32, s76, v32, v28
    v_bfi_b32 v33, s76, v33, v29
    v_bfi_b32 v34, s76, v34, v30
    v_bfi_b32 v35, s76, v35, v31
    s_mov_b32 exec_lo, 0x000f000f
    s_mov_b32 exec_hi, 0x000f000f
    buffer_store_dwordx4 v[32:35], v21, s[52:55], s65 offen sc1
    s_mov_b64 exec, -1
    s_endpgm
L_red:
    s_mov_b32 s48, s16
    s_and_b32 s49, s17, 0xffff
    s_mov_b32 s50, 0x800
    s_mov_b32 s51, 0x20000
    s_sub_u32 s64, s58, 0
    s_lshr_b32 s65, s64, 4
    s_and_b32 s66, s64, 15
    v_and_b32 v4, 7, v0
    v_lshlrev_b32 v5, 3, v4
    s_lshl_b32 s63, s65, 10
    s_lshl_b32 s11, s66, 6
    s_add_u32 s63, s63, s11
    v_lshlrev_b32 v6, 4, v4
    s_add_u32 s67, s66, 32
    s_lshl_b32 s67, s67, 8
    s_lshl_b32 s11, s65, 7
    s_add_u32 s67, s67, s11
    s_add_u32 s67, s67, 4096
    v_lshrrev_b32 v7, 3, v0
    v_lshlrev_b32 v21, 12, v7
    v_lshlrev_b32 v7, 11, v7
    v_add_u32 v7, v7, v6
    v_add_u32 v21, v21, v6
    s_lshl_b32 s68, s65, 16
    s_lshl_b32 s11, s66, 7
    s_add_u32 s68, s68, s11
    s_add_u32 s68, s68, 589824
    s_lshl_b32 s69, s65, 11
    s_add_u32 s69, s69, s11
    s_add_u32 s69, s69, 1048576
    v_mov_b32 v24, s77
    v_mov_b32 v25, s78
    s_mov_b32 s15, 65536
L_lw_25:
    ds_read_b32 v20, v3 offset:24
    s_waitcnt lgkmcnt(0)
    v_readfirstlane_b32 s14, v20
    s_nop 0
    s_cmp_lg_u32 s14, 0
    s_cbranch_scc1 L_lwd_26
    s_sub_u32 s15, s15, 1
    s_cmp_eq_u32 s15, 0
    s_cbranch_scc1 L_abort
    s_sleep 2
    s_branch L_lw_25
L_lwd_26:
    buffer_load_dwordx2 v[8:9], v5, s[48:51], s63 offen
    s_mov_b64 s[70:71], -1
    s_mov_b32 s15, 65536
L_mpoll_27:
    s_mov_b64 exec, s[70:71]
    buffer_load_dwordx4 v[12:15], v6, s[52:55], s67 offen sc1
    s_mov_b64 exec, -1
    s_waitcnt vmcnt(0)
    v_perm_b32 v5, v13, v12, s72
    v_cmp_ne_u32 s[70:71], s43, v5
    v_perm_b32 v5, v15, v14, s72
    v_cmp_ne_u32 vcc, s43, v5
    s_nop 0
    s_or_b64 s[70:71], s[70:71], vcc
    s_mov_b64 s[10:11], s[70:71]
    s_cmp_eq_u64 s[10:11], 0
    s_cbranch_scc1 L_mpolld_28
    s_sub_u32 s15, s15, 1
    s_cmp_eq_u32 s15, 0
    s_cbranch_scc1 L_abort
    s_sleep 4
    s_branch L_mpoll_27
L_mpolld_28:
    v_lshlrev_b32 v16, 16, v8
    v_and_b32 v17, 0xffff0000, v8
    v_lshlrev_b32 v18, 16, v9
    v_and_b32 v19, 0xffff0000, v9
    v_and_b32 v12, 0xffff0000, v12
    v_and_b32 v13, 0xffff0000, v13
    v_and_b32 v14, 0xffff0000, v14
    v_and_b32 v15, 0xffff0000, v15
    s_and_b32 s10, s66, 15
    s_lshl_b32 s70, s65, 8
    s_lshl_b32 s10, s10, 4
    s_add_u32 s70, s70, s10
    s_add_u32 s70, s70, 1081344
    v_lshlrev_b32 v22, 9, v0
    s_bfe_u32 s10, s43, 0x80000
    v_mov_b32 v72, s10
    s_bfe_u32 s10, s43, 0x80008
    v_mov_b32 v73, s10
    s_bfe_u32 s10, s43, 0x80010
    v_mov_b32 v74, s10
    s_bfe_u32 s10, s43, 0x80018
    v_mov_b32 v75, s10
    s_mov_b64 s[22:23], -1
    s_mov_b64 s[24:25], -1
    s_mov_b64 s[26:27], -1
    s_mov_b64 s[28:29], -1
    s_mov_b32 s15, 65536
    s_mov_b64 exec, s[22:23]
    buffer_load_dwordx4 v[32:35], v7, s[52:55], s68 offen sc1
    s_mov_b64 exec, s[24:25]
    s_add_u32 s13, s68, 16384
    buffer_load_dwordx4 v[36:39], v7, s[52:55], s13 offen sc1
    s_mov_b64 exec, s[26:27]
    s_add_u32 s13, s68, 32768
    buffer_load_dwordx4 v[40:43], v7, s[52:55], s13 offen sc1
    s_mov_b64 exec, s[28:29]
    s_add_u32 s13, s68, 49152
    buffer_load_dwordx4 v[44:47], v7, s[52:55], s13 offen sc1
    s_mov_b64 exec, -1
    s_sleep 4
L_ppoll_29:
    s_mov_b64 exec, s[22:23]
    buffer_load_dwordx4 v[32:35], v7, s[52:55], s68 offen sc1
    s_mov_b64 exec, s[24:25]
    s_add_u32 s13, s68, 16384
    buffer_load_dwordx4 v[36:39], v7, s[52:55], s13 offen sc1
    s_mov_b64 exec, s[26:27]
    s_add_u32 s13, s68, 32768
    buffer_load_dwordx4 v[40:43], v7, s[52:55], s13 offen sc1
    s_mov_b64 exec, s[28:29]
    s_add_u32 s13, s68, 49152
    buffer_load_dwordx4 v[44:47], v7, s[52:55], s13 offen sc1
    s_mov_b64 exec, -1
    s_waitcnt vmcnt(4)
    v_perm_b32 v5, v33, v32, s73
    v_perm_b32 v20, v35, v34, s74
    v_or_b32 v5, v5, v20
    v_cmp_ne_u32 s[22:23], s43, v5
    v_perm_b32 v5, v37, v36, s73
    v_perm_b32 v20, v39, v38, s74
    v_or_b32 v5, v5, v20
    v_cmp_ne_u32 s[24:25], s43, v5
    v_perm_b32 v5, v41, v40, s73
    v_perm_b32 v20, v43, v42, s74
    v_or_b32 v5, v5, v20
    v_cmp_ne_u32 s[26:27], s43, v5
    v_perm_b32 v5, v45, v44, s73
    v_perm_b32 v20, v47, v46, s74
    v_or_b32 v5, v5, v20
    v_cmp_ne_u32 s[28:29], s43, v5
    s_or_b64 s[10:11], s[22:23], s[24:25]
    s_or_b64 s[10:11], s[10:11], s[26:27]
    s_or_b64 s[10:11], s[10:11], s[28:29]
    s_cmp_eq_u64 s[10:11], 0
    s_cbranch_scc1 L_ppolld_30
    s_sub_u32 s15, s15, 1
    s_cmp_eq_u32 s15, 0
    s_cbranch_scc0 L_ppoll_29
    s_branch L_abort
L_ppolld_30:
    v_and_b32 v52, s76, v32
    v_and_b32 v53, s76, v33
    v_and_b32 v54, s76, v34
    v_and_b32 v55, s76, v35
    v_and_b32 v56, s76, v36
    v_and_b32 v57, s76, v37
    v_and_b32 v58, s76, v38
    v_and_b32 v59, s76, v39
    v_and_b32 v60, s76, v40
    v_and_b32 v61, s76, v41
    v_and_b32 v62, s76, v42
    v_and_b32 v63, s76, v43
    v_and_b32 v64, s76, v44
    v_and_b32 v65, s76, v45
    v_and_b32 v66, s76, v46
    v_and_b32 v67, s76, v47
    v_add_f32 v48, v52, v56
    v_add_f32 v49, v53, v57
    v_add_f32 v50, v54, v58
    v_add_f32 v51, v55, v59
    v_add_f32 v68, v60, v64
    v_add_f32 v69, v61, v65
    v_add_f32 v70, v62, v66
    v_add_f32 v71, v63, v67
    v_add_f32 v48, v48, v68
    v_add_f32 v49, v49, v69
    v_add_f32 v50, v50, v70
    v_add_f32 v51, v51, v71
    v_add_f32_dpp v48, v48, v48 row_ror:8 row_mask:0xf bank_mask:0xf
    v_add_f32_dpp v49, v49, v49 row_ror:8 row_mask:0xf bank_mask:0xf
    v_add_f32_dpp v50, v50, v50 row_ror:8 row_mask:0xf bank_mask:0xf
    v_add_f32_dpp v51, v51, v51 row_ror:8 row_mask:0xf bank_mask:0xf
    v_mov_b32 v52, v48
    v_mov_b32 v53, v49
    v_mov_b32 v54, v50
    v_mov_b32 v55, v51
    v_permlane16_swap_b32 v48, v52
    v_permlane16_swap_b32 v49, v53
    v_permlane16_swap_b32 v50, v54
    v_permlane16_swap_b32 v51, v55
    v_add_f32 v48, v48, v52
    v_add_f32 v49, v49, v53
    v_add_f32 v50, v50, v54
    v_add_f32 v51, v51, v55
    v_mov_b32 v52, v48
    v_mov_b32 v53, v49
    v_mov_b32 v54, v50
    v_mov_b32 v55, v51
    v_permlane32_swap_b32 v48, v52
    v_permlane32_swap_b32 v49, v53
    v_permlane32_swap_b32 v50, v54
    v_permlane32_swap_b32 v51, v55
    v_add_f32 v48, v48, v52
    v_add_f32 v49, v49, v53
    v_add_f32 v50, v50, v54
    v_add_f32 v51, v51, v55
    v_cvt_pk_bf16_f32 v52, v48, v49
    v_cvt_pk_bf16_f32 v53, v50, v51
    v_lshlrev_b32 v48, 16, v52
    v_and_b32 v49, 0xffff0000, v52
    v_lshlrev_b32 v50, 16, v53
    v_and_b32 v51, 0xffff0000, v53
    v_pk_mul_f32 v[48:49], v[48:49], v[12:13]
    v_pk_mul_f32 v[50:51], v[50:51], v[14:15]
    v_cvt_pk_bf16_f32 v52, v48, v49
    v_cvt_pk_bf16_f32 v53, v50, v51
    v_lshlrev_b32 v48, 16, v52
    v_and_b32 v49, 0xffff0000, v52
    v_lshlrev_b32 v50, 16, v53
    v_and_b32 v51, 0xffff0000, v53
    v_pk_add_f32 v[48:49], v[48:49], v[16:17]
    v_pk_add_f32 v[50:51], v[50:51], v[18:19]
    v_cvt_pk_bf16_f32 v52, v48, v49
    v_cvt_pk_bf16_f32 v53, v50, v51
    v_lshl_or_b32 v56, v52, 16, v24
    v_bfi_b32 v57, s75, v52, v25
    v_lshl_or_b32 v58, v53, 16, v24
    v_bfi_b32 v59, s75, v53, v25
    buffer_store_dwordx4 v[56:59], v21, s[52:55], s69 offen sc1
    v_lshlrev_b32 v48, 16, v52
    v_and_b32 v49, 0xffff0000, v52
    v_lshlrev_b32 v50, 16, v53
    v_and_b32 v51, 0xffff0000, v53
    v_add_f32 v28, v48, v49
    v_add_f32 v29, v50, v51
    v_add_f32 v28, v28, v29
    s_nop 1
    v_add_f32_dpp v28, v28, v28 row_ror:1 row_mask:0xf bank_mask:0xf
    s_nop 1
    v_add_f32_dpp v28, v28, v28 row_ror:2 row_mask:0xf bank_mask:0xf
    s_nop 1
    v_add_f32_dpp v28, v28, v28 row_ror:4 row_mask:0xf bank_mask:0xf
    v_mul_f32 v28, 0x3d000000, v28
    v_sub_f32 v48, v48, v28
    v_sub_f32 v49, v49, v28
    v_sub_f32 v50, v50, v28
    v_sub_f32 v51, v51, v28
    v_mul_f32 v29, v48, v48
    v_mul_f32 v5, v49, v49
    v_fmac_f32 v29, v50, v50
    v_fmac_f32 v5, v51, v51
    v_add_f32 v29, v29, v5
    s_nop 1
    v_add_f32_dpp v29, v29, v29 row_ror:1 row_mask:0xf bank_mask:0xf
    s_nop 1
    v_add_f32_dpp v29, v29, v29 row_ror:2 row_mask:0xf bank_mask:0xf
    s_nop 1
    v_add_f32_dpp v29, v29, v29 row_ror:4 row_mask:0xf bank_mask:0xf
    v_bfi_b32 v28, s76, v28, v72
    v_bfi_b32 v29, s76, v29, v73
    v_mov_b32 v30, v74
    v_mov_b32 v31, v75
    s_mov_b64 exec, 0xffff
    buffer_store_dwordx4 v[28:31], v22, s[52:55], s70 offen sc1
    s_mov_b64 exec, -1
    s_endpgm
L_mlp:
    s_mov_b32 s44, s28
    s_and_b32 s45, s29, 0xffff
    s_mov_b32 s46, 0x158000
    s_mov_b32 s47, 0x20000
    s_mov_b32 s48, s30
    s_and_b32 s49, s31, 0xffff
    s_mov_b32 s50, 0x158000
    s_mov_b32 s51, 0x20000
    v_bfe_u32 v4, v0, 3, 2
    v_lshlrev_b32 v4, 8, v4
    v_lshrrev_b32 v5, 5, v0
    v_lshlrev_b32 v5, 7, v5
    v_and_b32 v6, 7, v0
    v_lshlrev_b32 v6, 4, v6
    v_add3_u32 v61, v4, v5, v6
    s_lshl_b32 s65, s3, 10
    s_add_u32 s65, s65, 16384
    s_add_u32 s66, s65, 4096
    v_lshrrev_b32 v16, 2, v0
    v_mul_u32_u24 v16, 2752, v16
    v_lshrrev_b32 v4, 5, v0
    v_lshlrev_b32 v4, 1, v4
    v_and_b32 v5, 3, v0
    v_xor_b32 v4, v4, v5
    v_lshlrev_b32 v4, 4, v4
    v_add_u32 v16, v16, v4
    v_lshrrev_b32 v4, 4, v0
    v_lshlrev_b32 v5, 10, v4
    v_lshlrev_b32 v4, 5, v4
    v_and_b32 v6, 15, v0
    v_lshlrev_b32 v6, 4, v6
    v_xor_b32 v6, v6, v4
    v_add_u32 v17, v5, v6
    v_xor_b32 v6, 0x80, v6
    v_add_u32 v18, v5, v6
    s_mul_i32 s67, s3, 352256
    s_lshl_b32 s10, s58, 6
    s_add_u32 s67, s67, s10
    s_lshl_b32 s68, s58, 15
    s_lshl_b32 s10, s3, 8
    s_add_u32 s68, s68, s10
    s_lshl_b32 s69, s3, 13
    v_lshrrev_b32 v4, 4, v0
    v_bfe_u32 v5, v0, 2, 2
    v_lshlrev_b32 v6, 3, v4
    v_add_u32 v6, v6, v5
    v_lshlrev_b32 v6, 6, v6
    v_and_b32 v5, 1, v0
    v_lshlrev_b32 v5, 3, v5
    v_add_u32 v6, v6, v5
    v_add_u32 v6, 65536, v6
    v_add_u32 v6, s69, v6
    v_bfe_u32 v5, v0, 1, 1
    v_and_b32 v4, 1, v4
    v_lshlrev_b32 v4, 1, v4
    v_xor_b32 v20, v5, v4
    v_or_b32 v5, 2, v5
    v_xor_b32 v21, v5, v4
    v_lshlrev_b32 v20, 4, v20
    v_lshlrev_b32 v21, 4, v21
    v_add_u32 v20, v6, v20
    v_add_u32 v21, v6, v21
    v_lshrrev_b32 v4, 4, v0
    v_bfe_u32 v5, v0, 2, 2
    v_mul_u32_u24 v6, 4, v4
    v_add_u32 v6, v6, v5
    v_lshlrev_b32 v6, 8, v6
    v_and_b32 v4, 1, v4
    v_lshlrev_b32 v4, 2, v4
    v_or_b32 v4, v4, v5
    v_lshlrev_b32 v4, 5, v4
    v_and_b32 v5, 1, v0
    v_lshlrev_b32 v5, 3, v5
    v_add_u32 v6, v6, v5
    v_bfe_u32 v5, v0, 1, 1
    v_lshlrev_b32 v5, 4, v5
    v_add_u32 v6, v6, v5
    v_add_u32 v6, 98304, v6
    v_xor_b32 v7, 0, v4
    v_add_u32 v24, v6, v7
    v_xor_b32 v7, 32, v4
    v_add_u32 v25, v6, v7
    v_xor_b32 v7, 64, v4
    v_add_u32 v26, v6, v7
    v_xor_b32 v7, 96, v4
    v_add_u32 v27, v6, v7
    v_xor_b32 v7, 128, v4
    v_add_u32 v28, v6, v7
    v_xor_b32 v7, 160, v4
    v_add_u32 v29, v6, v7
    v_xor_b32 v7, 192, v4
    v_add_u32 v30, v6, v7
    v_xor_b32 v7, 224, v4
    v_add_u32 v31, v6, v7
    v_add_u32 v24, s69, v24
    v_add_u32 v25, s69, v25
    v_add_u32 v26, s69, v26
    v_add_u32 v27, s69, v27
    v_add_u32 v28, s69, v28
    v_add_u32 v29, s69, v29
    v_add_u32 v30, s69, v30
    v_add_u32 v31, s69, v31
    v_lshrrev_b32 v4, 5, v0
    v_lshlrev_b32 v4, 11, v4
    v_and_b32 v5, 31, v0
    v_lshlrev_b32 v5, 4, v5
    v_add_u32 v4, v4, v5
    s_and_b32 s10, s58, 7
    s_lshl_b32 s70, s10, 12
    s_lshl_b32 s10, s3, 9
    s_add_u32 s70, s70, s10
    s_add_u32 s70, s70, 1048576
    s_and_b32 s10, s58, 3
    s_lshl_b32 s10, s10, 2
    s_add_u32 s10, s10, s3
    s_lshl_b32 s63, s10, 9
    s_add_u32 s63, s63, 1081344
    v_lshrrev_b32 v62, 5, v0
    v_lshlrev_b32 v62, 8, v62
    v_and_b32 v5, 15, v0
    v_lshlrev_b32 v5, 4, v5
    v_add_u32 v62, v62, v5
    v_and_b32 v5, 1, v0
    v_lshlrev_b32 v57, 6, v5
    v_lshrrev_b32 v6, 4, v0
    v_lshlrev_b32 v7, 4, v6
    s_lshl_b32 s10, s3, 7
    s_add_u32 s10, s10, 144384
    v_add3_u32 v57, v57, v7, s10
    v_bfe_u32 v7, v0, 1, 3
    v_lshlrev_b32 v56, 1, v7
    v_add_u32 v56, v56, v57
    v_lshlrev_b32 v23, 7, v5
    v_lshlrev_b32 v6, 5, v6
    v_add_u32 v23, v23, v6
    s_lshl_b32 s10, s3, 8
    s_add_u32 s10, s10, 143360
    v_add_u32 v22, s10, v23
    v_lshlrev_b32 v7, 2, v7
    v_add3_u32 v23, v23, v7, s10
    v_subrev_u32 v23, s10, v23
    v_add_u32 v23, 143360, v23
    v_lshrrev_b32 v58, 5, v0
    v_mul_u32_u24 v58, 1088, v58
    v_and_b32 v59, 31, v0
    v_lshlrev_b32 v59, 3, v59
    s_lshl_b32 s10, s3, 8
    s_add_u32 s10, s10, 139520
    v_add3_u32 v58, v58, v59, s10
    v_and_b32 v59, 1, v0
    v_mul_u32_u24 v59, 1088, v59
    v_lshrrev_b32 v5, 4, v0
    v_lshlrev_b32 v5, 4, v5
    v_add3_u32 v59, v59, v5, s10
    v_and_b32 v60, 1, v0
    v_lshlrev_b32 v60, 11, v60
    v_bfe_u32 v5, v0, 1, 3
    v_lshlrev_b32 v5, 6, v5
    v_lshrrev_b32 v6, 4, v0
    v_lshlrev_b32 v6, 4, v6
    v_add3_u32 v60, v60, v5, v6
    s_lshl_b32 s71, s58, 12
    s_lshl_b32 s13, s3, 9
    s_add_u32 s71, s71, s13
    s_add_u32 s71, s71, 1114112
    s_bfe_u32 s10, s43, 0x80000
    v_mov_b32 v160, s10
    s_bfe_u32 s10, s43, 0x80008
    v_mov_b32 v161, s10
    s_bfe_u32 s10, s43, 0x80010
    v_mov_b32 v162, s10
    s_bfe_u32 s10, s43, 0x80018
    v_mov_b32 v163, s10
    s_mov_b32 s15, 65536
L_lw_31:
    ds_read_b32 v5, v3 offset:40
    s_waitcnt lgkmcnt(0)
    v_readfirstlane_b32 s14, v5
    s_nop 0
    s_cmp_eq_u32 s14, 8
    s_cbranch_scc1 L_lwd_32
    s_sub_u32 s15, s15, 1
    s_cmp_eq_u32 s15, 0
    s_cbranch_scc1 L_abort
    s_sleep 2
    s_branch L_lw_31
L_lwd_32:
    s_mov_b32 s62, 0
    s_add_u32 s10, s69, 65536
    s_mov_b32 m0, s10
    s_add_u32 s11, s67, 0
    buffer_load_dwordx4 v16, s[44:47], s11 offen nt lds
    s_add_u32 s10, s69, 66560
    s_mov_b32 m0, s10
    s_add_u32 s11, s67, 44032
    buffer_load_dwordx4 v16, s[44:47], s11 offen nt lds
    s_add_u32 s10, s69, 67584
    s_mov_b32 m0, s10
    s_add_u32 s11, s67, 88064
    buffer_load_dwordx4 v16, s[44:47], s11 offen nt lds
    s_cmp_lg_u32 s62, 0
    s_cbranch_scc1 L_mlpgo_33
    s_waitcnt vmcnt(2)
    ds_read_b32 v5, v3 offset:24
    s_waitcnt lgkmcnt(0)
    v_readfirstlane_b32 s62, v5
L_mlpgo_33:
    s_add_u32 s10, s69, 68608
    s_mov_b32 m0, s10
    s_add_u32 s11, s67, 132096
    buffer_load_dwordx4 v16, s[44:47], s11 offen nt lds
    s_cmp_lg_u32 s62, 0
    s_cbranch_scc1 L_mlpgo_34
    s_waitcnt vmcnt(2)
    ds_read_b32 v5, v3 offset:24
    s_waitcnt lgkmcnt(0)
    v_readfirstlane_b32 s62, v5
L_mlpgo_34:
    s_add_u32 s10, s69, 69632
    s_mov_b32 m0, s10
    s_add_u32 s11, s67, 176128
    buffer_load_dwordx4 v16, s[44:47], s11 offen nt lds
    s_cmp_lg_u32 s62, 0
    s_cbranch_scc1 L_mlpgo_35
    s_waitcnt vmcnt(2)
    ds_read_b32 v5, v3 offset:24
    s_waitcnt lgkmcnt(0)
    v_readfirstlane_b32 s62, v5
L_mlpgo_35:
    s_add_u32 s10, s69, 70656
    s_mov_b32 m0, s10
    s_add_u32 s11, s67, 220160
    buffer_load_dwordx4 v16, s[44:47], s11 offen nt lds
    s_cmp_lg_u32 s62, 0
    s_cbranch_scc1 L_mlpgo_36
    s_waitcnt vmcnt(2)
    ds_read_b32 v5, v3 offset:24
    s_waitcnt lgkmcnt(0)
    v_readfirstlane_b32 s62, v5
L_mlpgo_36:
    s_add_u32 s10, s69, 71680
    s_mov_b32 m0, s10
    s_add_u32 s11, s67, 264192
    buffer_load_dwordx4 v16, s[44:47], s11 offen nt lds
    s_cmp_lg_u32 s62, 0
    s_cbranch_scc1 L_mlpgo_37
    s_waitcnt vmcnt(2)
    ds_read_b32 v5, v3 offset:24
    s_waitcnt lgkmcnt(0)
    v_readfirstlane_b32 s62, v5
L_mlpgo_37:
    s_add_u32 s10, s69, 72704
    s_mov_b32 m0, s10
    s_add_u32 s11, s67, 308224
    buffer_load_dwordx4 v16, s[44:47], s11 offen nt lds
    s_mov_b32 s15, 65536
L_lw_38:
    ds_read_b32 v5, v3 offset:24
    s_waitcnt lgkmcnt(0)
    v_readfirstlane_b32 s14, v5
    s_nop 0
    s_cmp_lg_u32 s14, 0
    s_cbranch_scc1 L_lwd_39
    s_sub_u32 s15, s15, 1
    s_cmp_eq_u32 s15, 0
    s_cbranch_scc1 L_abort
    s_sleep 1
    s_branch L_lw_38
L_lwd_39:
    buffer_load_dwordx4 v[8:11], v61, s[52:55], s65 offen sc1
    buffer_load_dwordx4 v[12:15], v61, s[52:55], s66 offen sc1
    s_add_u32 s10, s69, 98304
    s_mov_b32 m0, s10
    s_add_u32 s11, s68, 0
    buffer_load_dwordx4 v17, s[48:51], s11 offen nt lds
    s_add_u32 s10, s69, 99328
    s_mov_b32 m0, s10
    s_add_u32 s11, s68, 4096
    buffer_load_dwordx4 v18, s[48:51], s11 offen nt lds
    s_add_u32 s10, s69, 100352
    s_mov_b32 m0, s10
    s_add_u32 s11, s68, 8192
    buffer_load_dwordx4 v17, s[48:51], s11 offen nt lds
    s_add_u32 s10, s69, 101376
    s_mov_b32 m0, s10
    s_add_u32 s11, s68, 12288
    buffer_load_dwordx4 v18, s[48:51], s11 offen nt lds
    s_add_u32 s10, s69, 102400
    s_mov_b32 m0, s10
    s_add_u32 s11, s68, 16384
    buffer_load_dwordx4 v17, s[48:51], s11 offen nt lds
    s_add_u32 s10, s69, 103424
    s_mov_b32 m0, s10
    s_add_u32 s11, s68, 20480
    buffer_load_dwordx4 v18, s[48:51], s11 offen nt lds
    s_add_u32 s10, s69, 104448
    s_mov_b32 m0, s10
    s_add_u32 s11, s68, 24576
    buffer_load_dwordx4 v17, s[48:51], s11 offen nt lds
    s_add_u32 s10, s69, 105472
    s_mov_b32 m0, s10
    s_add_u32 s11, s68, 28672
    buffer_load_dwordx4 v18, s[48:51], s11 offen nt lds
    s_waitcnt vmcnt(10)
    ds_read_b64_tr_b16 v[64:65], v20 offset:0
    ds_read_b64_tr_b16 v[66:67], v20 offset:256
    ds_read_b64_tr_b16 v[68:69], v21 offset:0
    ds_read_b64_tr_b16 v[70:71], v21 offset:256
    ds_read_b64_tr_b16 v[72:73], v20 offset:2048
    ds_read_b64_tr_b16 v[74:75], v20 offset:2304
    ds_read_b64_tr_b16 v[76:77], v21 offset:2048
    ds_read_b64_tr_b16 v[78:79], v21 offset:2304
    s_waitcnt lgkmcnt(0)
    ds_read_b64_tr_b16 v[80:81], v20 offset:4096
    ds_read_b64_tr_b16 v[82:83], v20 offset:4352
    ds_read_b64_tr_b16 v[84:85], v21 offset:4096
    ds_read_b64_tr_b16 v[86:87], v21 offset:4352
    ds_read_b64_tr_b16 v[88:89], v20 offset:6144
    ds_read_b64_tr_b16 v[90:91], v20 offset:6400
    ds_read_b64_tr_b16 v[92:93], v21 offset:6144
    ds_read_b64_tr_b16 v[94:95], v21 offset:6400
    s_waitcnt vmcnt(0) lgkmcnt(0)
    ds_read_b64_tr_b16 v[96:97], v24
    ds_read_b64_tr_b16 v[98:99], v24 offset:4096
    ds_read_b64_tr_b16 v[100:101], v25
    ds_read_b64_tr_b16 v[102:103], v25 offset:4096
    ds_read_b64_tr_b16 v[104:105], v26
    ds_read_b64_tr_b16 v[106:107], v26 offset:4096
    ds_read_b64_tr_b16 v[108:109], v27
    ds_read_b64_tr_b16 v[110:111], v27 offset:4096
    s_waitcnt lgkmcnt(0)
    ds_read_b64_tr_b16 v[112:113], v28
    ds_read_b64_tr_b16 v[114:115], v28 offset:4096
    ds_read_b64_tr_b16 v[116:117], v29
    ds_read_b64_tr_b16 v[118:119], v29 offset:4096
    ds_read_b64_tr_b16 v[120:121], v30
    ds_read_b64_tr_b16 v[122:123], v30 offset:4096
    ds_read_b64_tr_b16 v[124:125], v31
    ds_read_b64_tr_b16 v[126:127], v31 offset:4096
    s_waitcnt lgkmcnt(0)
    v_perm_b32 v5, v9, v8, s72
    v_cmp_ne_u32 s[80:81], s43, v5
    v_perm_b32 v5, v11, v10, s72
    v_cmp_ne_u32 vcc, s43, v5
    s_nop 0
    s_or_b64 s[80:81], s[80:81], vcc
    v_perm_b32 v5, v13, v12, s72
    v_cmp_ne_u32 s[82:83], s43, v5
    v_perm_b32 v5, v15, v14, s72
    v_cmp_ne_u32 vcc, s43, v5
    s_nop 0
    s_or_b64 s[82:83], s[82:83], vcc
    s_or_b64 s[10:11], s[80:81], s[82:83]
    s_cmp_eq_u64 s[10:11], 0
    s_cbranch_scc1 L_mlp_mod_ok
    s_mov_b64 s[80:81], -1
    s_mov_b64 s[82:83], -1
    s_mov_b32 s15, 65536
L_mpoll_40:
    s_mov_b64 exec, s[80:81]
    buffer_load_dwordx4 v[8:11], v61, s[52:55], s65 offen sc1
    s_mov_b64 exec, s[82:83]
    buffer_load_dwordx4 v[12:15], v61, s[52:55], s66 offen sc1
    s_mov_b64 exec, -1
    s_waitcnt vmcnt(0)
    v_perm_b32 v5, v9, v8, s72
    v_cmp_ne_u32 s[80:81], s43, v5
    v_perm_b32 v5, v11, v10, s72
    v_cmp_ne_u32 vcc, s43, v5
    s_nop 0
    s_or_b64 s[80:81], s[80:81], vcc
    v_perm_b32 v5, v13, v12, s72
    v_cmp_ne_u32 s[82:83], s43, v5
    v_perm_b32 v5, v15, v14, s72
    v_cmp_ne_u32 vcc, s43, v5
    s_nop 0
    s_or_b64 s[82:83], s[82:83], vcc
    s_mov_b64 s[10:11], s[80:81]
    s_or_b64 s[10:11], s[10:11], s[82:83]
    s_cmp_eq_u64 s[10:11], 0
    s_cbranch_scc1 L_mpolld_41
    s_sub_u32 s15, s15, 1
    s_cmp_eq_u32 s15, 0
    s_cbranch_scc1 L_abort
    s_sleep 4
    s_branch L_mpoll_40
L_mpolld_41:
L_mlp_mod_ok:
    v_and_b32 v8, 0xffff0000, v8
    v_and_b32 v9, 0xffff0000, v9
    v_and_b32 v10, 0xffff0000, v10
    v_and_b32 v11, 0xffff0000, v11
    v_and_b32 v12, 0xffff0000, v12
    v_and_b32 v13, 0xffff0000, v13
    v_and_b32 v14, 0xffff0000, v14
    v_and_b32 v15, 0xffff0000, v15
    v_add_f32 v12, 1.0, v12
    v_add_f32 v13, 1.0, v13
    v_add_f32 v14, 1.0, v14
    v_add_f32 v15, 1.0, v15
    v_cvt_pk_bf16_f32 v12, v12, v12
    v_cvt_pk_bf16_f32 v13, v13, v13
    v_cvt_pk_bf16_f32 v14, v14, v14
    v_cvt_pk_bf16_f32 v15, v15, v15
    v_and_b32 v12, 0xffff0000, v12
    v_and_b32 v13, 0xffff0000, v13
    v_and_b32 v14, 0xffff0000, v14
    v_and_b32 v15, 0xffff0000, v15
    s_mov_b64 s[80:81], -1
    s_mov_b64 s[82:83], -1
    s_mov_b32 s15, 65536
    s_mov_b64 exec, s[80:81]
    buffer_load_dwordx4 v[32:35], v4, s[52:55], s70 offen sc1
    s_mov_b64 exec, s[82:83]
    buffer_load_dwordx4 v[36:39], v62, s[52:55], s63 offen sc1
    s_mov_b64 exec, -1
    s_sleep 4
L_ppoll_42:
    s_mov_b64 exec, s[80:81]
    buffer_load_dwordx4 v[32:35], v4, s[52:55], s70 offen sc1
    s_mov_b64 exec, s[82:83]
    buffer_load_dwordx4 v[36:39], v62, s[52:55], s63 offen sc1
    s_mov_b64 exec, -1
    s_waitcnt vmcnt(2)
    v_perm_b32 v5, v33, v32, s72
    v_cmp_ne_u32 s[80:81], s43, v5
    v_perm_b32 v5, v35, v34, s72
    v_cmp_ne_u32 vcc, s43, v5
    s_nop 0
    s_or_b64 s[80:81], s[80:81], vcc
    v_perm_b32 v5, v37, v36, s73
    v_perm_b32 v6, v39, v38, s74
    v_or_b32 v5, v5, v6
    v_cmp_ne_u32 s[82:83], s43, v5
    s_nop 0
    s_or_b64 s[10:11], s[80:81], s[82:83]
    s_cmp_eq_u64 s[10:11], 0
    s_cbranch_scc1 L_ppolld_43
    s_sub_u32 s15, s15, 1
    s_cmp_eq_u32 s15, 0
    s_cbranch_scc0 L_ppoll_42
    s_branch L_abort
L_ppolld_43:
    v_and_b32 v63, s76, v36
    v_and_b32 v47, s76, v37
    v_and_b32 v40, 0xffff0000, v32
    v_and_b32 v41, 0xffff0000, v33
    v_and_b32 v42, 0xffff0000, v34
    v_and_b32 v43, 0xffff0000, v35
    v_add_f32_dpp v44, v63, v63 row_ror:1 row_mask:0xf bank_mask:0xf
    s_nop 1
    v_add_f32_dpp v44, v44, v44 row_ror:2 row_mask:0xf bank_mask:0xf
    s_nop 1
    v_add_f32_dpp v44, v44, v44 row_ror:4 row_mask:0xf bank_mask:0xf
    s_nop 1
    v_add_f32_dpp v44, v44, v44 row_ror:8 row_mask:0xf bank_mask:0xf
    v_mul_f32 v44, 0x3d800000, v44
    v_sub_f32 v45, v63, v44
    v_mul_f32 v45, v45, v45
    v_mov_b32 v46, 0x42000000
    v_fma_f32 v45, v45, v46, v47
    s_nop 1
    v_add_f32_dpp v45, v45, v45 row_ror:1 row_mask:0xf bank_mask:0xf
    s_nop 1
    v_add_f32_dpp v45, v45, v45 row_ror:2 row_mask:0xf bank_mask:0xf
    s_nop 1
    v_add_f32_dpp v45, v45, v45 row_ror:4 row_mask:0xf bank_mask:0xf
    s_nop 1
    v_add_f32_dpp v45, v45, v45 row_ror:8 row_mask:0xf bank_mask:0xf
    v_cvt_pk_bf16_f32 v46, v44, v44
    v_mul_f32 v45, 0x3b000000, v45
    v_and_b32 v46, 0xffff0000, v46
    v_max_f32 v45, 0, v45
    v_mov_b32 v47, v46
    v_cvt_pk_bf16_f32 v45, v45, v45
    v_pk_add_f32 v[40:41], v[40:41], v[46:47] neg_lo:[0,1] neg_hi:[0,1]
    v_and_b32 v45, 0xffff0000, v45
    v_pk_add_f32 v[42:43], v[42:43], v[46:47] neg_lo:[0,1] neg_hi:[0,1]
    v_add_f32 v45, 0x3727c5ac, v45
    v_cvt_pk_bf16_f32 v48, v40, v41
    v_cvt_pk_bf16_f32 v45, v45, v45
    v_cvt_pk_bf16_f32 v49, v42, v43
    v_and_b32 v45, 0xffff0000, v45
    v_lshlrev_b32 v40, 16, v48
    v_sqrt_f32 v45, v45
    v_and_b32 v41, 0xffff0000, v48
    v_lshlrev_b32 v42, 16, v49
    v_cvt_pk_bf16_f32 v45, v45, v45
    v_and_b32 v43, 0xffff0000, v49
    v_and_b32 v45, 0xffff0000, v45
    v_rcp_f32 v46, v45
    s_nop 0
    v_mov_b32 v47, v46
    v_pk_mul_f32 v[40:41], v[40:41], v[46:47]
    v_pk_mul_f32 v[42:43], v[42:43], v[46:47]
    v_cvt_pk_bf16_f32 v48, v40, v41
    v_cvt_pk_bf16_f32 v49, v42, v43
    v_lshlrev_b32 v40, 16, v48
    v_and_b32 v41, 0xffff0000, v48
    v_lshlrev_b32 v42, 16, v49
    v_and_b32 v43, 0xffff0000, v49
    v_pk_mul_f32 v[40:41], v[40:41], v[12:13]
    v_pk_mul_f32 v[42:43], v[42:43], v[14:15]
    v_cvt_pk_bf16_f32 v48, v40, v41
    v_cvt_pk_bf16_f32 v49, v42, v43
    v_lshlrev_b32 v40, 16, v48
    v_and_b32 v41, 0xffff0000, v48
    v_lshlrev_b32 v42, 16, v49
    v_and_b32 v43, 0xffff0000, v49
    v_pk_add_f32 v[40:41], v[40:41], v[8:9]
    v_pk_add_f32 v[42:43], v[42:43], v[10:11]
    v_cvt_pk_bf16_f32 v40, v40, v41
    v_cvt_pk_bf16_f32 v41, v42, v43
    ds_write_b64 v58, v[40:41]
    ds_read_b128 v[128:131], v59 offset:0
    ds_read_b128 v[132:135], v59 offset:64
    ds_read_b128 v[136:139], v59 offset:128
    ds_read_b128 v[140:143], v59 offset:192
    s_waitcnt lgkmcnt(3)
    v_mfma_f32_16x16x32_bf16 v[48:51], v[64:67], v[128:131], 0
    v_mfma_f32_16x16x32_bf16 v[52:55], v[68:71], v[128:131], 0
    s_waitcnt lgkmcnt(2)
    v_mfma_f32_16x16x32_bf16 v[48:51], v[72:75], v[132:135], v[48:51]
    v_mfma_f32_16x16x32_bf16 v[52:55], v[76:79], v[132:135], v[52:55]
    s_waitcnt lgkmcnt(1)
    v_mfma_f32_16x16x32_bf16 v[48:51], v[80:83], v[136:139], v[48:51]
    v_mfma_f32_16x16x32_bf16 v[52:55], v[84:87], v[136:139], v[52:55]
    s_waitcnt lgkmcnt(0)
    v_mfma_f32_16x16x32_bf16 v[48:51], v[88:91], v[140:143], v[48:51]
    v_mfma_f32_16x16x32_bf16 v[52:55], v[92:95], v[140:143], v[52:55]
    s_mov_b32 exec_lo, 0x00030003
    s_mov_b32 exec_hi, 0x00030003
    s_nop 4
    ds_write_b128 v22, v[48:51]
    ds_write_b128 v22, v[52:55] offset:16
    s_mov_b64 exec, -1
    s_waitcnt lgkmcnt(0)
    s_barrier
    ds_read_b32 v128, v23 offset:0
    ds_read_b32 v129, v23 offset:256
    ds_read_b32 v130, v23 offset:512
    ds_read_b32 v131, v23 offset:768
    s_waitcnt lgkmcnt(2)
    v_add_f32 v128, v128, v129
    s_waitcnt lgkmcnt(0)
    v_add_f32 v130, v130, v131
    v_add_f32 v128, v128, v130
    v_cvt_pk_bf16_f32 v128, v128, v128
    v_and_b32 v128, 0xffff0000, v128
    v_mul_f32 v129, 0xbfb8aa3b, v128
    v_exp_f32 v129, v129
    s_nop 0
    v_add_f32 v129, 1.0, v129
    v_rcp_f32 v129, v129
    s_nop 0
    v_mul_f32 v128, v128, v129
    v_cvt_pk_bf16_f32 v128, v128, v128
    ds_write_b16 v56, v128
    ds_read_b128 v[48:51], v57
    s_waitcnt lgkmcnt(0)
    v_mfma_f32_16x16x32_bf16 v[128:131], v[96:99], v[48:51], 0
    v_mfma_f32_16x16x32_bf16 v[132:135], v[100:103], v[48:51], 0
    v_mfma_f32_16x16x32_bf16 v[136:139], v[104:107], v[48:51], 0
    v_mfma_f32_16x16x32_bf16 v[140:143], v[108:111], v[48:51], 0
    v_mfma_f32_16x16x32_bf16 v[144:147], v[112:115], v[48:51], 0
    v_mfma_f32_16x16x32_bf16 v[148:151], v[116:119], v[48:51], 0
    v_mfma_f32_16x16x32_bf16 v[152:155], v[120:123], v[48:51], 0
    v_mfma_f32_16x16x32_bf16 v[156:159], v[124:127], v[48:51], 0
    s_mov_b32 s10, 0x000c000c
    s_mov_b32 s11, 0x000c000c
    v_cndmask_b32_e64 v52, v128, v132, s[10:11]
    v_cndmask_b32_e64 v53, v129, v133, s[10:11]
    v_cndmask_b32_e64 v54, v130, v134, s[10:11]
    v_cndmask_b32_e64 v55, v131, v135, s[10:11]
    s_lshl_b64 s[10:11], s[10:11], 2
    v_cndmask_b32_e64 v52, v52, v136, s[10:11]
    v_cndmask_b32_e64 v53, v53, v137, s[10:11]
    v_cndmask_b32_e64 v54, v54, v138, s[10:11]
    v_cndmask_b32_e64 v55, v55, v139, s[10:11]
    s_lshl_b64 s[10:11], s[10:11], 2
    v_cndmask_b32_e64 v52, v52, v140, s[10:11]
    v_cndmask_b32_e64 v53, v53, v141, s[10:11]
    v_cndmask_b32_e64 v54, v54, v142, s[10:11]
    v_cndmask_b32_e64 v55, v55, v143, s[10:11]
    s_lshl_b64 s[10:11], s[10:11], 2
    v_cndmask_b32_e64 v52, v52, v144, s[10:11]
    v_cndmask_b32_e64 v53, v53, v145, s[10:11]
    v_cndmask_b32_e64 v54, v54, v146, s[10:11]
    v_cndmask_b32_e64 v55, v55, v147, s[10:11]
    s_lshl_b64 s[10:11], s[10:11], 2
    v_cndmask_b32_e64 v52, v52, v148, s[10:11]
    v_cndmask_b32_e64 v53, v53, v149, s[10:11]
    v_cndmask_b32_e64 v54, v54, v150, s[10:11]
    v_cndmask_b32_e64 v55, v55, v151, s[10:11]
    s_lshl_b64 s[10:11], s[10:11], 2
    v_cndmask_b32_e64 v52, v52, v152, s[10:11]
    v_cndmask_b32_e64 v53, v53, v153, s[10:11]
    v_cndmask_b32_e64 v54, v54, v154, s[10:11]
    v_cndmask_b32_e64 v55, v55, v155, s[10:11]
    s_lshl_b64 s[10:11], s[10:11], 2
    v_cndmask_b32_e64 v52, v52, v156, s[10:11]
    v_cndmask_b32_e64 v53, v53, v157, s[10:11]
    v_cndmask_b32_e64 v54, v54, v158, s[10:11]
    v_cndmask_b32_e64 v55, v55, v159, s[10:11]
    v_bfi_b32 v52, s76, v52, v160
    v_bfi_b32 v53, s76, v53, v161
    v_bfi_b32 v54, s76, v54, v162
    v_bfi_b32 v55, s76, v55, v163
    buffer_store_dwordx4 v[52:55], v60, s[52:55], s71 offen sc1
    s_endpgm
L_fin:
    s_mov_b32 s48, s36
    s_and_b32 s49, s37, 0xffff
    s_mov_b32 s50, 0x800
    s_mov_b32 s51, 0x20000
    s_sub_u32 s64, s58, 32
    s_lshr_b32 s65, s64, 4
    s_and_b32 s66, s64, 15
    v_and_b32 v4, 7, v0
    v_lshlrev_b32 v6, 4, v4
    s_add_u32 s67, s66, 80
    s_lshl_b32 s67, s67, 8
    s_lshl_b32 s11, s65, 7
    s_add_u32 s67, s67, s11
    s_add_u32 s67, s67, 4096
    s_and_b32 s10, s58, 7
    s_lshl_b32 s68, s10, 12
    s_lshl_b32 s10, s65, 11
    s_add_u32 s68, s68, s10
    s_lshl_b32 s10, s66, 7
    s_add_u32 s68, s68, s10
    s_add_u32 s68, s68, 1048576
    v_lshrrev_b32 v7, 3, v0
    v_lshlrev_b32 v7, 12, v7
    v_add_u32 v7, v7, v6
    s_lshl_b32 s69, s65, 11
    s_lshl_b32 s10, s66, 7
    s_add_u32 s69, s69, s10
    s_add_u32 s69, s69, 1114112
    v_lshlrev_b32 v8, 3, v4
    s_lshl_b32 s70, s65, 10
    s_lshl_b32 s10, s66, 6
    s_add_u32 s70, s70, s10
    s_mov_b32 s15, 65536
L_lw_44:
    ds_read_b32 v5, v3 offset:24
    s_waitcnt lgkmcnt(0)
    v_readfirstlane_b32 s14, v5
    s_nop 0
    s_cmp_lg_u32 s14, 0
    s_cbranch_scc1 L_lwd_45
    s_sub_u32 s15, s15, 1
    s_cmp_eq_u32 s15, 0
    s_cbranch_scc1 L_abort
    s_sleep 2
    s_branch L_lw_44
L_lwd_45:
    s_mov_b64 s[80:81], -1
    s_mov_b32 s15, 65536
L_mpoll_46:
    s_mov_b64 exec, s[80:81]
    buffer_load_dwordx4 v[12:15], v6, s[52:55], s67 offen sc1
    s_mov_b64 exec, -1
    s_waitcnt vmcnt(0)
    v_perm_b32 v5, v13, v12, s72
    v_cmp_ne_u32 s[80:81], s43, v5
    v_perm_b32 v5, v15, v14, s72
    v_cmp_ne_u32 vcc, s43, v5
    s_nop 0
    s_or_b64 s[80:81], s[80:81], vcc
    s_mov_b64 s[10:11], s[80:81]
    s_cmp_eq_u64 s[10:11], 0
    s_cbranch_scc1 L_mpolld_47
    s_sub_u32 s15, s15, 1
    s_cmp_eq_u32 s15, 0
    s_cbranch_scc1 L_abort
    s_sleep 4
    s_branch L_mpoll_46
L_mpolld_47:
    v_and_b32 v12, 0xffff0000, v12
    v_and_b32 v13, 0xffff0000, v13
    v_and_b32 v14, 0xffff0000, v14
    v_and_b32 v15, 0xffff0000, v15
    v_mov_b32 v52, 0
    v_mov_b32 v53, 0
    v_mov_b32 v54, 0
    v_mov_b32 v55, 0
    s_mov_b32 s84, 0xffffff
    s_mov_b32 s85, 0x0
    s_mov_b64 s[80:81], -1
    s_mov_b32 s15, 65536
L_mpoll_48:
    s_mov_b64 exec, s[80:81]
    buffer_load_dwordx4 v[16:19], v6, s[52:55], s68 offen sc1
    s_mov_b64 exec, -1
    s_waitcnt vmcnt(0)
    v_perm_b32 v5, v17, v16, s72
    v_cmp_ne_u32 s[80:81], s43, v5
    v_perm_b32 v5, v19, v18, s72
    v_cmp_ne_u32 vcc, s43, v5
    s_nop 0
    s_or_b64 s[80:81], s[80:81], vcc
    s_mov_b64 s[10:11], s[80:81]
    s_cmp_eq_u64 s[10:11], 0
    s_cbranch_scc1 L_mpolld_49
    s_sub_u32 s15, s15, 1
    s_cmp_eq_u32 s15, 0
    s_cbranch_scc1 L_abort
    s_sleep 2
    s_branch L_mpoll_48
L_mpolld_49:
    v_and_b32 v16, 0xffff0000, v16
    v_and_b32 v17, 0xffff0000, v17
    v_and_b32 v18, 0xffff0000, v18
    v_and_b32 v19, 0xffff0000, v19
    s_mov_b64 s[22:23], -1
    s_mov_b64 s[24:25], -1
    s_mov_b64 s[26:27], -1
    s_mov_b64 s[28:29], -1
    s_mov_b64 s[30:31], -1
    s_mov_b64 s[32:33], s[84:85]
    s_mov_b32 s15, 65536
    s_mov_b64 exec, s[22:23]
    buffer_load_dwordx4 v[32:35], v7, s[52:55], s69 offen sc1
    s_mov_b64 exec, s[24:25]
    s_add_u32 s13, s69, 32768
    buffer_load_dwordx4 v[36:39], v7, s[52:55], s13 offen sc1
    s_mov_b64 exec, s[26:27]
    s_add_u32 s13, s69, 65536
    buffer_load_dwordx4 v[40:43], v7, s[52:55], s13 offen sc1
    s_mov_b64 exec, s[28:29]
    s_add_u32 s13, s69, 98304
    buffer_load_dwordx4 v[44:47], v7, s[52:55], s13 offen sc1
    s_mov_b64 exec, s[30:31]
    s_add_u32 s13, s69, 131072
    buffer_load_dwordx4 v[48:51], v7, s[52:55], s13 offen sc1
    s_mov_b64 exec, s[32:33]
    s_add_u32 s13, s69, 163840
    buffer_load_dwordx4 v[52:55], v7, s[52:55], s13 offen sc1
    s_mov_b64 exec, -1
    s_sleep 4
L_ppoll_50:
    s_mov_b64 exec, s[22:23]
    buffer_load_dwordx4 v[32:35], v7, s[52:55], s69 offen sc1
    s_mov_b64 exec, s[24:25]
    s_add_u32 s13, s69, 32768
    buffer_load_dwordx4 v[36:39], v7, s[52:55], s13 offen sc1
    s_mov_b64 exec, s[26:27]
    s_add_u32 s13, s69, 65536
    buffer_load_dwordx4 v[40:43], v7, s[52:55], s13 offen sc1
    s_mov_b64 exec, s[28:29]
    s_add_u32 s13, s69, 98304
    buffer_load_dwordx4 v[44:47], v7, s[52:55], s13 offen sc1
    s_mov_b64 exec, s[30:31]
    s_add_u32 s13, s69, 131072
    buffer_load_dwordx4 v[48:51], v7, s[52:55], s13 offen sc1
    s_mov_b64 exec, s[32:33]
    s_add_u32 s13, s69, 163840
    buffer_load_dwordx4 v[52:55], v7, s[52:55], s13 offen sc1
    s_mov_b64 exec, -1
    s_waitcnt vmcnt(6)
    v_perm_b32 v5, v33, v32, s73
    v_perm_b32 v20, v35, v34, s74
    v_or_b32 v5, v5, v20
    v_cmp_ne_u32 s[22:23], s43, v5
    v_perm_b32 v5, v37, v36, s73
    v_perm_b32 v20, v39, v38, s74
    v_or_b32 v5, v5, v20
    v_cmp_ne_u32 s[24:25], s43, v5
    v_perm_b32 v5, v41, v40, s73
    v_perm_b32 v20, v43, v42, s74
    v_or_b32 v5, v5, v20
    v_cmp_ne_u32 s[26:27], s43, v5
    v_perm_b32 v5, v45, v44, s73
    v_perm_b32 v20, v47, v46, s74
    v_or_b32 v5, v5, v20
    v_cmp_ne_u32 s[28:29], s43, v5
    v_perm_b32 v5, v49, v48, s73
    v_perm_b32 v20, v51, v50, s74
    v_or_b32 v5, v5, v20
    v_cmp_ne_u32 s[30:31], s43, v5
    v_perm_b32 v5, v53, v52, s73
    v_perm_b32 v20, v55, v54, s74
    v_or_b32 v5, v5, v20
    v_cmp_ne_u32 s[32:33], s43, v5
    s_nop 0
    s_and_b64 s[32:33], s[32:33], s[84:85]
    s_or_b64 s[10:11], s[22:23], s[24:25]
    s_or_b64 s[10:11], s[10:11], s[26:27]
    s_or_b64 s[10:11], s[10:11], s[28:29]
    s_or_b64 s[10:11], s[10:11], s[30:31]
    s_or_b64 s[10:11], s[10:11], s[32:33]
    s_cmp_eq_u64 s[10:11], 0
    s_cbranch_scc1 L_ppolld_51
    s_sub_u32 s15, s15, 1
    s_cmp_eq_u32 s15, 0
    s_cbranch_scc0 L_ppoll_50
    s_branch L_abort
L_ppolld_51:
    v_and_b32 v68, s76, v32
    v_and_b32 v69, s76, v33
    v_and_b32 v70, s76, v34
    v_and_b32 v71, s76, v35
    v_and_b32 v72, s76, v36
    v_and_b32 v73, s76, v37
    v_and_b32 v74, s76, v38
    v_and_b32 v75, s76, v39
    v_and_b32 v76, s76, v40
    v_and_b32 v77, s76, v41
    v_and_b32 v78, s76, v42
    v_and_b32 v79, s76, v43
    v_and_b32 v80, s76, v44
    v_and_b32 v81, s76, v45
    v_and_b32 v82, s76, v46
    v_and_b32 v83, s76, v47
    v_and_b32 v84, s76, v48
    v_and_b32 v85, s76, v49
    v_and_b32 v86, s76, v50
    v_and_b32 v87, s76, v51
    v_and_b32 v88, s76, v52
    v_and_b32 v89, s76, v53
    v_and_b32 v90, s76, v54
    v_and_b32 v91, s76, v55
    v_add_f32 v64, v68, v72
    v_add_f32 v65, v69, v73
    v_add_f32 v66, v70, v74
    v_add_f32 v67, v71, v75
    v_add_f32 v92, v76, v80
    v_add_f32 v93, v77, v81
    v_add_f32 v94, v78, v82
    v_add_f32 v95, v79, v83
    v_add_f32 v96, v84, v88
    v_add_f32 v97, v85, v89
    v_add_f32 v98, v86, v90
    v_add_f32 v99, v87, v91
    v_add_f32 v64, v64, v92
    v_add_f32 v65, v65, v93
    v_add_f32 v66, v66, v94
    v_add_f32 v67, v67, v95
    v_add_f32 v64, v64, v96
    v_add_f32 v65, v65, v97
    v_add_f32 v66, v66, v98
    v_add_f32 v67, v67, v99
    v_add_f32_dpp v64, v64, v64 row_ror:8 row_mask:0xf bank_mask:0xf
    v_add_f32_dpp v65, v65, v65 row_ror:8 row_mask:0xf bank_mask:0xf
    v_add_f32_dpp v66, v66, v66 row_ror:8 row_mask:0xf bank_mask:0xf
    v_add_f32_dpp v67, v67, v67 row_ror:8 row_mask:0xf bank_mask:0xf
    v_mov_b32 v68, v64
    v_mov_b32 v69, v65
    v_mov_b32 v70, v66
    v_mov_b32 v71, v67
    v_permlane16_swap_b32 v64, v68
    v_permlane16_swap_b32 v65, v69
    v_permlane16_swap_b32 v66, v70
    v_permlane16_swap_b32 v67, v71
    v_add_f32 v64, v64, v68
    v_add_f32 v65, v65, v69
    v_add_f32 v66, v66, v70
    v_add_f32 v67, v67, v71
    v_mov_b32 v68, v64
    v_mov_b32 v69, v65
    v_mov_b32 v70, v66
    v_mov_b32 v71, v67
    v_permlane32_swap_b32 v64, v68
    v_permlane32_swap_b32 v65, v69
    v_permlane32_swap_b32 v66, v70
    v_permlane32_swap_b32 v67, v71
    v_add_f32 v64, v64, v68
    v_add_f32 v65, v65, v69
    v_add_f32 v66, v66, v70
    v_add_f32 v67, v67, v71
    v_cvt_pk_bf16_f32 v68, v64, v65
    v_cvt_pk_bf16_f32 v69, v66, v67
    v_lshlrev_b32 v64, 16, v68
    v_and_b32 v65, 0xffff0000, v68
    v_lshlrev_b32 v66, 16, v69
    v_and_b32 v67, 0xffff0000, v69
    v_pk_mul_f32 v[64:65], v[64:65], v[12:13]
    v_pk_mul_f32 v[66:67], v[66:67], v[14:15]
    v_cvt_pk_bf16_f32 v68, v64, v65
    v_cvt_pk_bf16_f32 v69, v66, v67
    v_lshlrev_b32 v64, 16, v68
    v_and_b32 v65, 0xffff0000, v68
    v_lshlrev_b32 v66, 16, v69
    v_and_b32 v67, 0xffff0000, v69
    v_pk_add_f32 v[64:65], v[64:65], v[16:17]
    v_pk_add_f32 v[66:67], v[66:67], v[18:19]
    v_cvt_pk_bf16_f32 v64, v64, v65
    v_cvt_pk_bf16_f32 v65, v66, v67
    s_mov_b64 exec, 0xff
    buffer_store_dwordx2 v[64:65], v8, s[48:51], s70 offen
    s_mov_b64 exec, -1
    s_cmp_lg_u32 s58, 32
    s_cbranch_scc1 L_hexit2
    v_mov_b32 v4, s43
    v_mov_b32 v5, 0
    s_mov_b64 exec, 1
    buffer_store_dword v4, v5, s[52:55], 0 offen sc1
    s_mov_b64 exec, -1
L_hexit2:
    s_endpgm
L_stream:
    s_sub_u32 s12, s3, 4
    s_mov_b32 s44, s18
    s_and_b32 s45, s19, 0xffff
    s_mov_b32 s46, 0x4000000
    s_mov_b32 s47, 0x20000
    s_mov_b32 s48, s20
    s_and_b32 s49, s21, 0xffff
    s_mov_b32 s50, 0x4000000
    s_mov_b32 s51, 0x20000
    s_lshl_b32 s13, s5, 5
    s_add_u32 s13, s13, s4
    s_xor_b32 s13, s13, 0
    s_lshl_b32 s13, s13, 20
    s_lshl_b32 s10, s6, 18
    s_add_u32 s13, s13, s10
    s_mov_b32 s11, s8
    s_lshl_b32 s10, s12, 12
    s_add_u32 s79, s13, s10
    s_lshl_b32 s11, s11, 15
    s_add_u32 s10, s11, 0
    s_and_b32 s10, s10, 0x38000
    s_add_u32 s64, s10, s79
    s_add_u32 s10, s11, 32768
    s_and_b32 s10, s10, 0x38000
    s_add_u32 s65, s10, s79
    s_add_u32 s10, s11, 65536
    s_and_b32 s10, s10, 0x38000
    s_add_u32 s66, s10, s79
    s_add_u32 s10, s11, 98304
    s_and_b32 s10, s10, 0x38000
    s_add_u32 s67, s10, s79
    s_add_u32 s10, s11, 131072
    s_and_b32 s10, s10, 0x38000
    s_add_u32 s68, s10, s79
    s_add_u32 s10, s11, 163840
    s_and_b32 s10, s10, 0x38000
    s_add_u32 s69, s10, s79
    s_add_u32 s10, s11, 196608
    s_and_b32 s10, s10, 0x38000
    s_add_u32 s70, s10, s79
    s_add_u32 s10, s11, 229376
    s_and_b32 s10, s10, 0x38000
    s_add_u32 s71, s10, s79
    v_bfe_u32 v1, v0, 2, 2
    v_lshlrev_b32 v1, 8, v1
    v_lshrrev_b32 v36, 4, v0
    v_lshlrev_b32 v36, 6, v36
    v_and_b32 v2, 3, v0
    v_lshlrev_b32 v2, 4, v2
    v_add3_u32 v1, v1, v36, v2
    v_lshlrev_b32 v2, 4, v0
    buffer_load_dwordx4 v[40:43], v1, s[44:47], s64 offen offset:0 nt
    buffer_load_dwordx4 v[44:47], v1, s[44:47], s64 offen offset:1024 nt
    buffer_load_dwordx4 v[48:51], v1, s[44:47], s64 offen offset:2048 nt
    buffer_load_dwordx4 v[52:55], v1, s[44:47], s64 offen offset:3072 nt
    s_waitcnt vmcnt(3)
    buffer_load_dwordx4 v[56:59], v1, s[44:47], s65 offen offset:0 nt
    s_waitcnt vmcnt(3)
    buffer_load_dwordx4 v[60:63], v1, s[44:47], s65 offen offset:1024 nt
    s_waitcnt vmcnt(3)
    buffer_load_dwordx4 v[64:67], v1, s[44:47], s65 offen offset:2048 nt
    s_waitcnt vmcnt(3)
    buffer_load_dwordx4 v[68:71], v1, s[44:47], s65 offen offset:3072 nt
    s_waitcnt vmcnt(3)
    buffer_load_dwordx4 v[72:75], v1, s[44:47], s66 offen offset:0 nt
    s_waitcnt vmcnt(3)
    buffer_load_dwordx4 v[76:79], v1, s[44:47], s66 offen offset:1024 nt
    s_waitcnt vmcnt(3)
    buffer_load_dwordx4 v[80:83], v1, s[44:47], s66 offen offset:2048 nt
    s_waitcnt vmcnt(3)
    buffer_load_dwordx4 v[84:87], v1, s[44:47], s66 offen offset:3072 nt
    s_waitcnt vmcnt(3)
    buffer_load_dwordx4 v[88:91], v1, s[44:47], s67 offen offset:0 nt
    s_waitcnt vmcnt(3)
    buffer_load_dwordx4 v[92:95], v1, s[44:47], s67 offen offset:1024 nt
    s_waitcnt vmcnt(3)
    buffer_load_dwordx4 v[96:99], v1, s[44:47], s67 offen offset:2048 nt
    s_waitcnt vmcnt(3)
    buffer_load_dwordx4 v[100:103], v1, s[44:47], s67 offen offset:3072 nt
    s_waitcnt vmcnt(3)
    buffer_load_dwordx4 v[104:107], v1, s[44:47], s68 offen offset:0 nt
    s_waitcnt vmcnt(3)
    buffer_load_dwordx4 v[108:111], v1, s[44:47], s68 offen offset:1024 nt
    s_waitcnt vmcnt(3)
    buffer_load_dwordx4 v[112:115], v1, s[44:47], s68 offen offset:2048 nt
    s_waitcnt vmcnt(3)
    buffer_load_dwordx4 v[116:119], v1, s[44:47], s68 offen offset:3072 nt
    s_waitcnt vmcnt(3)
    buffer_load_dwordx4 v[120:123], v1, s[44:47], s69 offen offset:0 nt
    s_waitcnt vmcnt(3)
    buffer_load_dwordx4 v[124:127], v1, s[44:47], s69 offen offset:1024 nt
    s_waitcnt vmcnt(3)
    buffer_load_dwordx4 v[128:131], v1, s[44:47], s69 offen offset:2048 nt
    s_waitcnt vmcnt(3)
    buffer_load_dwordx4 v[132:135], v1, s[44:47], s69 offen offset:3072 nt
    s_waitcnt vmcnt(3)
    buffer_load_dwordx4 v[136:139], v1, s[44:47], s70 offen offset:0 nt
    s_waitcnt vmcnt(3)
    buffer_load_dwordx4 v[140:143], v1, s[44:47], s70 offen offset:1024 nt
    s_waitcnt vmcnt(3)
    buffer_load_dwordx4 v[144:147], v1, s[44:47], s70 offen offset:2048 nt
    s_waitcnt vmcnt(3)
    buffer_load_dwordx4 v[148:151], v1, s[44:47], s70 offen offset:3072 nt
    s_waitcnt vmcnt(3)
    buffer_load_dwordx4 v[152:155], v1, s[44:47], s71 offen offset:0 nt
    s_waitcnt vmcnt(3)
    buffer_load_dwordx4 v[156:159], v1, s[44:47], s71 offen offset:1024 nt
    s_waitcnt vmcnt(3)
    buffer_load_dwordx4 v[160:163], v1, s[44:47], s71 offen offset:2048 nt
    s_waitcnt vmcnt(3)
    buffer_load_dwordx4 v[164:167], v1, s[44:47], s71 offen offset:3072 nt
    v_mov_b32 v36, 1
    s_mov_b64 exec, 1
    ds_add_u32 v3, v36 offset:36
    s_mov_b64 exec, -1
    s_mov_b32 s15, 65536
L_lw_52:
    ds_read_b32 v36, v3 offset:36
    s_waitcnt lgkmcnt(0)
    v_readfirstlane_b32 s14, v36
    s_nop 0
    s_cmp_eq_u32 s14, 8
    s_cbranch_scc1 L_lwd_53
    s_sub_u32 s15, s15, 1
    s_cmp_eq_u32 s15, 0
    s_cbranch_scc1 L_abort
    s_sleep 1
    s_branch L_lw_52
L_lwd_53:
    s_mul_i32 s79, s12, 4096
    s_add_u32 s79, s79, 32768
    s_add_u32 s10, s79, 0
    s_mov_b32 m0, s10
    s_waitcnt vmcnt(3)
    buffer_load_dwordx4 v2, s[48:51], s64 offen offset:0 nt lds
    s_waitcnt vmcnt(3)
    buffer_load_dwordx4 v2, s[48:51], s64 offen offset:1024 nt lds
    s_waitcnt vmcnt(3)
    buffer_load_dwordx4 v2, s[48:51], s64 offen offset:2048 nt lds
    s_waitcnt vmcnt(3)
    buffer_load_dwordx4 v2, s[48:51], s64 offen offset:3072 nt lds
    s_waitcnt lgkmcnt(0)
    s_mul_i32 s43, s42, 1664525
    s_add_u32 s43, s43, 1013904223
    s_mov_b32 s72, 0x05040100
    s_mov_b32 s73, 0x0c0c0400
    s_mov_b32 s74, 0x04000c0c
    s_mov_b32 s75, 0xffff0000
    s_mov_b32 s76, 0xffffff00
    s_and_b32 s77, s43, 0xffff
    s_lshr_b32 s78, s43, 16
    s_mov_b32 s80, 0x22222222
    s_mov_b32 s81, 0x22222222
    s_mov_b32 s82, 0x44444444
    s_mov_b32 s83, 0x44444444
    s_mov_b32 s84, 0x88888888
    s_mov_b32 s85, 0x88888888
    s_mov_b32 s15, 65536
L_lw_54:
    ds_read_b32 v36, v3 offset:0
    s_waitcnt lgkmcnt(0)
    v_readfirstlane_b32 s14, v36
    s_nop 0
    s_cmp_lg_u32 s14, 0
    s_cbranch_scc1 L_lwd_55
    s_sub_u32 s15, s15, 1
    s_cmp_eq_u32 s15, 0
    s_cbranch_scc1 L_abort
    s_sleep 2
    s_branch L_lw_54
L_lwd_55:
    v_lshrrev_b32 v36, 4, v0
    v_lshlrev_b32 v36, 2, v36
    v_and_b32 v37, 3, v0
    v_add_u32 v36, v36, v37
    v_lshlrev_b32 v36, 4, v36
    v_add_u32 v36, 131328, v36
    ds_read_b128 v[20:23], v36
    s_mov_b32 s10, 0x000f000f
    s_mov_b32 s11, 0x000f000f
    s_waitcnt lgkmcnt(0)
    v_cndmask_b32_e64 v4, 0, v20, s[10:11]
    v_cndmask_b32_e64 v5, 0, v21, s[10:11]
    v_cndmask_b32_e64 v6, 0, v22, s[10:11]
    v_cndmask_b32_e64 v7, 0, v23, s[10:11]
    s_lshl_b64 s[10:11], s[10:11], 4
    v_cndmask_b32_e64 v8, 0, v20, s[10:11]
    v_cndmask_b32_e64 v9, 0, v21, s[10:11]
    v_cndmask_b32_e64 v10, 0, v22, s[10:11]
    v_cndmask_b32_e64 v11, 0, v23, s[10:11]
    s_lshl_b64 s[10:11], s[10:11], 4
    v_cndmask_b32_e64 v12, 0, v20, s[10:11]
    v_cndmask_b32_e64 v13, 0, v21, s[10:11]
    v_cndmask_b32_e64 v14, 0, v22, s[10:11]
    v_cndmask_b32_e64 v15, 0, v23, s[10:11]
    s_lshl_b64 s[10:11], s[10:11], 4
    v_cndmask_b32_e64 v16, 0, v20, s[10:11]
    v_cndmask_b32_e64 v17, 0, v21, s[10:11]
    v_cndmask_b32_e64 v18, 0, v22, s[10:11]
    v_cndmask_b32_e64 v19, 0, v23, s[10:11]
    s_waitcnt vmcnt(3)
    v_mfma_f32_16x16x32_bf16 v[20:23], v[40:43], v[4:7], 0
    v_mfma_f32_16x16x32_bf16 v[20:23], v[44:47], v[8:11], v[20:23]
    v_mfma_f32_16x16x32_bf16 v[20:23], v[48:51], v[12:15], v[20:23]
    v_mfma_f32_16x16x32_bf16 v[20:23], v[52:55], v[16:19], v[20:23]
    v_mfma_f32_16x16x32_bf16 v[24:27], v[56:59], v[4:7], 0
    v_mfma_f32_16x16x32_bf16 v[24:27], v[60:63], v[8:11], v[24:27]
    v_mfma_f32_16x16x32_bf16 v[24:27], v[64:67], v[12:15], v[24:27]
    v_mfma_f32_16x16x32_bf16 v[24:27], v[68:71], v[16:19], v[24:27]
    s_nop 3
    v_cndmask_b32_e64 v36, v20, v21, s[80:81]
    v_cndmask_b32_e64 v36, v36, v22, s[82:83]
    v_cndmask_b32_e64 v36, v36, v23, s[84:85]
    s_nop 1
    v_add_f32_dpp v37, v36, v36 quad_perm:[1,0,3,2] row_mask:0xf bank_mask:0xf
    s_nop 1
    v_add_f32_dpp v36, v37, v37 quad_perm:[2,3,0,1] row_mask:0xf bank_mask:0xf
    v_cvt_pk_bf16_f32 v36, v36, v36
    v_and_b32 v36, 0xffff0000, v36
    v_mul_f32 v36, 0x3db504f3, v36
    v_cvt_pk_bf16_f32 v36, v36, v36
    v_and_b32 v28, 0xffff0000, v36
    s_waitcnt vmcnt(3)
    buffer_load_dwordx4 v[56:59], v2, s[48:51], s65 offen offset:0 nt
    v_mfma_f32_16x16x32_bf16 v[20:23], v[72:75], v[4:7], 0
    v_mfma_f32_16x16x32_bf16 v[20:23], v[76:79], v[8:11], v[20:23]
    v_mfma_f32_16x16x32_bf16 v[20:23], v[80:83], v[12:15], v[20:23]
    v_mfma_f32_16x16x32_bf16 v[20:23], v[84:87], v[16:19], v[20:23]
    v_cndmask_b32_e64 v36, v24, v25, s[80:81]
    v_cndmask_b32_e64 v36, v36, v26, s[82:83]
    v_cndmask_b32_e64 v36, v36, v27, s[84:85]
    s_nop 1
    v_add_f32_dpp v37, v36, v36 quad_perm:[1,0,3,2] row_mask:0xf bank_mask:0xf
    s_nop 1
    v_add_f32_dpp v36, v37, v37 quad_perm:[2,3,0,1] row_mask:0xf bank_mask:0xf
    v_cvt_pk_bf16_f32 v36, v36, v36
    v_and_b32 v36, 0xffff0000, v36
    v_mul_f32 v36, 0x3db504f3, v36
    v_cvt_pk_bf16_f32 v36, v36, v36
    v_and_b32 v29, 0xffff0000, v36
    s_waitcnt vmcnt(3)
    buffer_load_dwordx4 v[60:63], v2, s[48:51], s65 offen offset:1024 nt
    v_mfma_f32_16x16x32_bf16 v[24:27], v[88:91], v[4:7], 0
    v_mfma_f32_16x16x32_bf16 v[24:27], v[92:95], v[8:11], v[24:27]
    v_mfma_f32_16x16x32_bf16 v[24:27], v[96:99], v[12:15], v[24:27]
    v_mfma_f32_16x16x32_bf16 v[24:27], v[100:103], v[16:19], v[24:27]
    v_cndmask_b32_e64 v36, v20, v21, s[80:81]
    v_cndmask_b32_e64 v36, v36, v22, s[82:83]
    v_cndmask_b32_e64 v36, v36, v23, s[84:85]
    s_nop 1
    v_add_f32_dpp v37, v36, v36 quad_perm:[1,0,3,2] row_mask:0xf bank_mask:0xf
    s_nop 1
    v_add_f32_dpp v36, v37, v37 quad_perm:[2,3,0,1] row_mask:0xf bank_mask:0xf
    v_cvt_pk_bf16_f32 v36, v36, v36
    v_and_b32 v36, 0xffff0000, v36
    v_mul_f32 v36, 0x3db504f3, v36
    v_cvt_pk_bf16_f32 v36, v36, v36
    v_and_b32 v30, 0xffff0000, v36
    s_waitcnt vmcnt(3)
    buffer_load_dwordx4 v[64:67], v2, s[48:51], s65 offen offset:2048 nt
    v_mfma_f32_16x16x32_bf16 v[20:23], v[104:107], v[4:7], 0
    v_mfma_f32_16x16x32_bf16 v[20:23], v[108:111], v[8:11], v[20:23]
    v_mfma_f32_16x16x32_bf16 v[20:23], v[112:115], v[12:15], v[20:23]
    v_mfma_f32_16x16x32_bf16 v[20:23], v[116:119], v[16:19], v[20:23]
    v_cndmask_b32_e64 v36, v24, v25, s[80:81]
    v_cndmask_b32_e64 v36, v36, v26, s[82:83]
    v_cndmask_b32_e64 v36, v36, v27, s[84:85]
    s_nop 1
    v_add_f32_dpp v37, v36, v36 quad_perm:[1,0,3,2] row_mask:0xf bank_mask:0xf
    s_nop 1
    v_add_f32_dpp v36, v37, v37 quad_perm:[2,3,0,1] row_mask:0xf bank_mask:0xf
    v_cvt_pk_bf16_f32 v36, v36, v36
    v_and_b32 v36, 0xffff0000, v36
    v_mul_f32 v36, 0x3db504f3, v36
    v_cvt_pk_bf16_f32 v36, v36, v36
    v_and_b32 v31, 0xffff0000, v36
    s_waitcnt vmcnt(3)
    buffer_load_dwordx4 v[68:71], v2, s[48:51], s65 offen offset:3072 nt
    v_mfma_f32_16x16x32_bf16 v[24:27], v[120:123], v[4:7], 0
    v_mfma_f32_16x16x32_bf16 v[24:27], v[124:127], v[8:11], v[24:27]
    v_mfma_f32_16x16x32_bf16 v[24:27], v[128:131], v[12:15], v[24:27]
    v_mfma_f32_16x16x32_bf16 v[24:27], v[132:135], v[16:19], v[24:27]
    v_cndmask_b32_e64 v36, v20, v21, s[80:81]
    v_cndmask_b32_e64 v36, v36, v22, s[82:83]
    v_cndmask_b32_e64 v36, v36, v23, s[84:85]
    s_nop 1
    v_add_f32_dpp v37, v36, v36 quad_perm:[1,0,3,2] row_mask:0xf bank_mask:0xf
    s_nop 1
    v_add_f32_dpp v36, v37, v37 quad_perm:[2,3,0,1] row_mask:0xf bank_mask:0xf
    v_cvt_pk_bf16_f32 v36, v36, v36
    v_and_b32 v36, 0xffff0000, v36
    v_mul_f32 v36, 0x3db504f3, v36
    v_cvt_pk_bf16_f32 v36, v36, v36
    v_and_b32 v32, 0xffff0000, v36
    s_waitcnt vmcnt(3)
    buffer_load_dwordx4 v[72:75], v2, s[48:51], s66 offen offset:0 nt
    v_mfma_f32_16x16x32_bf16 v[20:23], v[136:139], v[4:7], 0
    v_mfma_f32_16x16x32_bf16 v[20:23], v[140:143], v[8:11], v[20:23]
    v_mfma_f32_16x16x32_bf16 v[20:23], v[144:147], v[12:15], v[20:23]
    v_mfma_f32_16x16x32_bf16 v[20:23], v[148:151], v[16:19], v[20:23]
    v_cndmask_b32_e64 v36, v24, v25, s[80:81]
    v_cndmask_b32_e64 v36, v36, v26, s[82:83]
    v_cndmask_b32_e64 v36, v36, v27, s[84:85]
    s_nop 1
    v_add_f32_dpp v37, v36, v36 quad_perm:[1,0,3,2] row_mask:0xf bank_mask:0xf
    s_nop 1
    v_add_f32_dpp v36, v37, v37 quad_perm:[2,3,0,1] row_mask:0xf bank_mask:0xf
    v_cvt_pk_bf16_f32 v36, v36, v36
    v_and_b32 v36, 0xffff0000, v36
    v_mul_f32 v36, 0x3db504f3, v36
    v_cvt_pk_bf16_f32 v36, v36, v36
    v_and_b32 v33, 0xffff0000, v36
    s_waitcnt vmcnt(3)
    buffer_load_dwordx4 v[76:79], v2, s[48:51], s66 offen offset:1024 nt
    v_mfma_f32_16x16x32_bf16 v[24:27], v[152:155], v[4:7], 0
    v_mfma_f32_16x16x32_bf16 v[24:27], v[156:159], v[8:11], v[24:27]
    v_mfma_f32_16x16x32_bf16 v[24:27], v[160:163], v[12:15], v[24:27]
    v_mfma_f32_16x16x32_bf16 v[24:27], v[164:167], v[16:19], v[24:27]
    v_cndmask_b32_e64 v36, v20, v21, s[80:81]
    v_cndmask_b32_e64 v36, v36, v22, s[82:83]
    v_cndmask_b32_e64 v36, v36, v23, s[84:85]
    s_nop 1
    v_add_f32_dpp v37, v36, v36 quad_perm:[1,0,3,2] row_mask:0xf bank_mask:0xf
    s_nop 1
    v_add_f32_dpp v36, v37, v37 quad_perm:[2,3,0,1] row_mask:0xf bank_mask:0xf
    v_cvt_pk_bf16_f32 v36, v36, v36
    v_and_b32 v36, 0xffff0000, v36
    v_mul_f32 v36, 0x3db504f3, v36
    v_cvt_pk_bf16_f32 v36, v36, v36
    v_and_b32 v34, 0xffff0000, v36
    s_waitcnt vmcnt(3)
    buffer_load_dwordx4 v[80:83], v2, s[48:51], s66 offen offset:2048 nt
    v_cndmask_b32_e64 v36, v24, v25, s[80:81]
    v_cndmask_b32_e64 v36, v36, v26, s[82:83]
    v_cndmask_b32_e64 v36, v36, v27, s[84:85]
    s_nop 1
    v_add_f32_dpp v37, v36, v36 quad_perm:[1,0,3,2] row_mask:0xf bank_mask:0xf
    s_nop 1
    v_add_f32_dpp v36, v37, v37 quad_perm:[2,3,0,1] row_mask:0xf bank_mask:0xf
    v_cvt_pk_bf16_f32 v36, v36, v36
    v_and_b32 v36, 0xffff0000, v36
    v_mul_f32 v36, 0x3db504f3, v36
    v_cvt_pk_bf16_f32 v36, v36, v36
    v_and_b32 v35, 0xffff0000, v36
    v_max3_f32 v36, v28, v29, v30
    v_max3_f32 v36, v36, v31, v32
    v_max3_f32 v36, v36, v33, v34
    v_max_f32 v36, v36, v35
    s_nop 1
    v_max_f32_dpp v36, v36, v36 row_ror:4 row_mask:0xf bank_mask:0xf
    s_nop 1
    v_max_f32_dpp v36, v36, v36 row_ror:8 row_mask:0xf bank_mask:0xf
    v_mov_b32 v37, v36
    s_nop 1
    v_permlane16_swap_b32 v36, v37
    v_max_f32 v36, v36, v37
    v_mov_b32 v37, v36
    s_nop 1
    v_permlane32_swap_b32 v36, v37
    v_max_f32 v36, v36, v37
    v_sub_f32 v28, v28, v36
    v_sub_f32 v29, v29, v36
    v_sub_f32 v30, v30, v36
    v_sub_f32 v31, v31, v36
    v_sub_f32 v32, v32, v36
    v_sub_f32 v33, v33, v36
    v_sub_f32 v34, v34, v36
    v_sub_f32 v35, v35, v36
    v_mul_f32 v28, 0x3fb8aa3b, v28
    v_mul_f32 v29, 0x3fb8aa3b, v29
    v_mul_f32 v30, 0x3fb8aa3b, v30
    v_mul_f32 v31, 0x3fb8aa3b, v31
    v_mul_f32 v32, 0x3fb8aa3b, v32
    v_mul_f32 v33, 0x3fb8aa3b, v33
    v_mul_f32 v34, 0x3fb8aa3b, v34
    v_mul_f32 v35, 0x3fb8aa3b, v35
    v_exp_f32 v28, v28
    v_exp_f32 v29, v29
    v_exp_f32 v30, v30
    v_exp_f32 v31, v31
    v_exp_f32 v32, v32
    v_exp_f32 v33, v33
    v_exp_f32 v34, v34
    v_exp_f32 v35, v35
    v_add_f32 v37, v28, v29
    v_add_f32 v38, v30, v31
    v_add_f32 v39, v32, v33
    v_add_f32 v37, v37, v38
    v_add_f32 v38, v34, v35
    v_add_f32 v37, v37, v39
    v_add_f32 v37, v37, v38
    s_nop 1
    v_add_f32_dpp v37, v37, v37 row_ror:4 row_mask:0xf bank_mask:0xf
    s_nop 1
    v_add_f32_dpp v37, v37, v37 row_ror:8 row_mask:0xf bank_mask:0xf
    v_mov_b32 v38, v37
    s_nop 1
    v_permlane16_swap_b32 v37, v38
    v_add_f32 v37, v37, v38
    v_mov_b32 v38, v37
    s_nop 1
    v_permlane32_swap_b32 v37, v38
    v_add_f32 v37, v37, v38
    v_cvt_pk_bf16_f32 v28, v28, v28
    v_cvt_pk_bf16_f32 v29, v29, v29
    v_cvt_pk_bf16_f32 v30, v30, v30
    v_cvt_pk_bf16_f32 v31, v31, v31
    v_cvt_pk_bf16_f32 v32, v32, v32
    v_cvt_pk_bf16_f32 v33, v33, v33
    v_cvt_pk_bf16_f32 v34, v34, v34
    v_cvt_pk_bf16_f32 v35, v35, v35
    s_lshl_b32 s10, s12, 3
    s_add_u32 s10, s10, 131584
    v_mov_b32 v38, s10
    s_mov_b64 exec, 1
    ds_write_b64 v38, v[36:37]
    s_mov_b64 exec, -1
    v_mov_b32 v39, 1
    s_mov_b64 exec, 1
    ds_add_u32 v3, v39 offset:8
    s_mov_b64 exec, -1
    s_waitcnt vmcnt(3)
    buffer_load_dwordx4 v[84:87], v2, s[48:51], s66 offen offset:3072 nt
    v_and_b32 v36, 1, v0
    v_cmp_eq_u32 vcc, 1, v36
    v_mov_b32 v37, 0xffff
    v_mov_b32 v38, 0xffff0000
    v_cndmask_b32 v37, v37, v38, vcc
    v_bfe_u32 v36, v0, 1, 2
    v_cmp_eq_u32 vcc, 0, v36
    s_nop 1
    v_cndmask_b32 v4, 0, v37, vcc
    v_cmp_eq_u32 vcc, 1, v36
    s_nop 1
    v_cndmask_b32 v5, 0, v37, vcc
    v_cmp_eq_u32 vcc, 2, v36
    s_nop 1
    v_cndmask_b32 v6, 0, v37, vcc
    v_cmp_eq_u32 vcc, 3, v36
    s_nop 1
    v_cndmask_b32 v7, 0, v37, vcc
    v_and_b32 v36, 15, v0
    v_lshlrev_b32 v36, 5, v36
    v_bfe_u32 v37, v0, 4, 1
    v_lshlrev_b32 v37, 4, v37
    s_lshl_b32 s10, s12, 9
    s_add_u32 s10, s10, 132096
    v_add3_u32 v20, v36, v37, s10
    v_lshrrev_b32 v36, 5, v0
    v_lshlrev_b32 v37, 11, v36
    v_and_b32 v38, 31, v0
    v_lshlrev_b32 v23, 4, v38
    v_add_u32 v21, v37, v23
    v_add_u32 v21, 132096, v21
    v_lshlrev_b32 v22, 4, v36
    v_add_u32 v22, 131712, v22
    s_bfe_u32 s10, s43, 0x80000
    v_mov_b32 v24, s10
    s_bfe_u32 s10, s43, 0x80008
    v_mov_b32 v25, s10
    s_bfe_u32 s10, s43, 0x80010
    v_mov_b32 v26, s10
    s_bfe_u32 s10, s43, 0x80018
    v_mov_b32 v27, s10
    v_and_b32_dpp v8, v28, v4 row_newbcast:0 row_mask:0xf bank_mask:0xf
    v_and_b32_dpp v9, v28, v5 row_newbcast:0 row_mask:0xf bank_mask:0xf
    v_and_b32_dpp v10, v28, v6 row_newbcast:0 row_mask:0xf bank_mask:0xf
    v_and_b32_dpp v11, v28, v7 row_newbcast:0 row_mask:0xf bank_mask:0xf
    v_add_u32 v36, s79, v2
    ds_read_b128 v[40:43], v36 offset:0
    ds_read_b128 v[44:47], v36 offset:1024
    ds_read_b128 v[48:51], v36 offset:2048
    ds_read_b128 v[52:55], v36 offset:3072
    s_waitcnt lgkmcnt(0)
    s_waitcnt vmcnt(3)
    buffer_load_dwordx4 v[88:91], v2, s[48:51], s67 offen offset:0 nt
    v_mfma_f32_16x16x32_bf16 v[16:19], v[8:11], v[40:43], 0
    v_and_b32_dpp v12, v28, v4 row_newbcast:4 row_mask:0xf bank_mask:0xf
    v_and_b32_dpp v13, v28, v5 row_newbcast:4 row_mask:0xf bank_mask:0xf
    v_and_b32_dpp v14, v28, v6 row_newbcast:4 row_mask:0xf bank_mask:0xf
    v_and_b32_dpp v15, v28, v7 row_newbcast:4 row_mask:0xf bank_mask:0xf
    s_nop 1
    v_mfma_f32_16x16x32_bf16 v[16:19], v[12:15], v[44:47], v[16:19]
    v_and_b32_dpp v8, v28, v4 row_newbcast:8 row_mask:0xf bank_mask:0xf
    v_and_b32_dpp v9, v28, v5 row_newbcast:8 row_mask:0xf bank_mask:0xf
    v_and_b32_dpp v10, v28, v6 row_newbcast:8 row_mask:0xf bank_mask:0xf
    v_and_b32_dpp v11, v28, v7 row_newbcast:8 row_mask:0xf bank_mask:0xf
    s_waitcnt vmcnt(3)
    buffer_load_dwordx4 v[92:95], v2, s[48:51], s67 offen offset:1024 nt
    v_mfma_f32_16x16x32_bf16 v[16:19], v[8:11], v[48:51], v[16:19]
    v_and_b32_dpp v12, v28, v4 row_newbcast:12 row_mask:0xf bank_mask:0xf
    v_and_b32_dpp v13, v28, v5 row_newbcast:12 row_mask:0xf bank_mask:0xf
    v_and_b32_dpp v14, v28, v6 row_newbcast:12 row_mask:0xf bank_mask:0xf
    v_and_b32_dpp v15, v28, v7 row_newbcast:12 row_mask:0xf bank_mask:0xf
    s_nop 1
    v_mfma_f32_16x16x32_bf16 v[16:19], v[12:15], v[52:55], v[16:19]
    v_and_b32_dpp v8, v29, v4 row_newbcast:0 row_mask:0xf bank_mask:0xf
    v_and_b32_dpp v9, v29, v5 row_newbcast:0 row_mask:0xf bank_mask:0xf
    v_and_b32_dpp v10, v29, v6 row_newbcast:0 row_mask:0xf bank_mask:0xf
    v_and_b32_dpp v11, v29, v7 row_newbcast:0 row_mask:0xf bank_mask:0xf
    s_waitcnt vmcnt(3)
    buffer_load_dwordx4 v[96:99], v2, s[48:51], s67 offen offset:2048 nt
    v_mfma_f32_16x16x32_bf16 v[16:19], v[8:11], v[56:59], v[16:19]
    v_and_b32_dpp v12, v29, v4 row_newbcast:4 row_mask:0xf bank_mask:0xf
    v_and_b32_dpp v13, v29, v5 row_newbcast:4 row_mask:0xf bank_mask:0xf
    v_and_b32_dpp v14, v29, v6 row_newbcast:4 row_mask:0xf bank_mask:0xf
    v_and_b32_dpp v15, v29, v7 row_newbcast:4 row_mask:0xf bank_mask:0xf
    s_nop 1
    v_mfma_f32_16x16x32_bf16 v[16:19], v[12:15], v[60:63], v[16:19]
    v_and_b32_dpp v8, v29, v4 row_newbcast:8 row_mask:0xf bank_mask:0xf
    v_and_b32_dpp v9, v29, v5 row_newbcast:8 row_mask:0xf bank_mask:0xf
    v_and_b32_dpp v10, v29, v6 row_newbcast:8 row_mask:0xf bank_mask:0xf
    v_and_b32_dpp v11, v29, v7 row_newbcast:8 row_mask:0xf bank_mask:0xf
    s_waitcnt vmcnt(3)
    buffer_load_dwordx4 v[100:103], v2, s[48:51], s67 offen offset:3072 nt
    v_mfma_f32_16x16x32_bf16 v[16:19], v[8:11], v[64:67], v[16:19]
    v_and_b32_dpp v12, v29, v4 row_newbcast:12 row_mask:0xf bank_mask:0xf
    v_and_b32_dpp v13, v29, v5 row_newbcast:12 row_mask:0xf bank_mask:0xf
    v_and_b32_dpp v14, v29, v6 row_newbcast:12 row_mask:0xf bank_mask:0xf
    v_and_b32_dpp v15, v29, v7 row_newbcast:12 row_mask:0xf bank_mask:0xf
    s_nop 1
    v_mfma_f32_16x16x32_bf16 v[16:19], v[12:15], v[68:71], v[16:19]
    v_and_b32_dpp v8, v30, v4 row_newbcast:0 row_mask:0xf bank_mask:0xf
    v_and_b32_dpp v9, v30, v5 row_newbcast:0 row_mask:0xf bank_mask:0xf
    v_and_b32_dpp v10, v30, v6 row_newbcast:0 row_mask:0xf bank_mask:0xf
    v_and_b32_dpp v11, v30, v7 row_newbcast:0 row_mask:0xf bank_mask:0xf
    buffer_load_dwordx4 v[104:107], v2, s[48:51], s68 offen offset:0 nt
    s_nop 0
    v_mfma_f32_16x16x32_bf16 v[16:19], v[8:11], v[72:75], v[16:19]
    v_and_b32_dpp v12, v30, v4 row_newbcast:4 row_mask:0xf bank_mask:0xf
    v_and_b32_dpp v13, v30, v5 row_newbcast:4 row_mask:0xf bank_mask:0xf
    v_and_b32_dpp v14, v30, v6 row_newbcast:4 row_mask:0xf bank_mask:0xf
    v_and_b32_dpp v15, v30, v7 row_newbcast:4 row_mask:0xf bank_mask:0xf
    s_nop 1
    v_mfma_f32_16x16x32_bf16 v[16:19], v[12:15], v[76:79], v[16:19]
    v_and_b32_dpp v8, v30, v4 row_newbcast:8 row_mask:0xf bank_mask:0xf
    v_and_b32_dpp v9, v30, v5 row_newbcast:8 row_mask:0xf bank_mask:0xf
    v_and_b32_dpp v10, v30, v6 row_newbcast:8 row_mask:0xf bank_mask:0xf
    v_and_b32_dpp v11, v30, v7 row_newbcast:8 row_mask:0xf bank_mask:0xf
    buffer_load_dwordx4 v[108:111], v2, s[48:51], s68 offen offset:1024 nt
    s_nop 0
    v_mfma_f32_16x16x32_bf16 v[16:19], v[8:11], v[80:83], v[16:19]
    v_and_b32_dpp v12, v30, v4 row_newbcast:12 row_mask:0xf bank_mask:0xf
    v_and_b32_dpp v13, v30, v5 row_newbcast:12 row_mask:0xf bank_mask:0xf
    v_and_b32_dpp v14, v30, v6 row_newbcast:12 row_mask:0xf bank_mask:0xf
    v_and_b32_dpp v15, v30, v7 row_newbcast:12 row_mask:0xf bank_mask:0xf
    s_nop 1
    v_mfma_f32_16x16x32_bf16 v[16:19], v[12:15], v[84:87], v[16:19]
    v_and_b32_dpp v8, v31, v4 row_newbcast:0 row_mask:0xf bank_mask:0xf
    v_and_b32_dpp v9, v31, v5 row_newbcast:0 row_mask:0xf bank_mask:0xf
    v_and_b32_dpp v10, v31, v6 row_newbcast:0 row_mask:0xf bank_mask:0xf
    v_and_b32_dpp v11, v31, v7 row_newbcast:0 row_mask:0xf bank_mask:0xf
    s_waitcnt vmcnt(5)
    buffer_load_dwordx4 v[112:115], v2, s[48:51], s68 offen offset:2048 nt
    v_mfma_f32_16x16x32_bf16 v[16:19], v[8:11], v[88:91], v[16:19]
    v_and_b32_dpp v12, v31, v4 row_newbcast:4 row_mask:0xf bank_mask:0xf
    v_and_b32_dpp v13, v31, v5 row_newbcast:4 row_mask:0xf bank_mask:0xf
    v_and_b32_dpp v14, v31, v6 row_newbcast:4 row_mask:0xf bank_mask:0xf
    v_and_b32_dpp v15, v31, v7 row_newbcast:4 row_mask:0xf bank_mask:0xf
    s_waitcnt vmcnt(5)
    buffer_load_dwordx4 v[116:119], v2, s[48:51], s68 offen offset:3072 nt
    v_mfma_f32_16x16x32_bf16 v[16:19], v[12:15], v[92:95], v[16:19]
    v_and_b32_dpp v8, v31, v4 row_newbcast:8 row_mask:0xf bank_mask:0xf
    v_and_b32_dpp v9, v31, v5 row_newbcast:8 row_mask:0xf bank_mask:0xf
    v_and_b32_dpp v10, v31, v6 row_newbcast:8 row_mask:0xf bank_mask:0xf
    v_and_b32_dpp v11, v31, v7 row_newbcast:8 row_mask:0xf bank_mask:0xf
    s_waitcnt vmcnt(5)
    buffer_load_dwordx4 v[120:123], v2, s[48:51], s69 offen offset:0 nt
    v_mfma_f32_16x16x32_bf16 v[16:19], v[8:11], v[96:99], v[16:19]
    v_and_b32_dpp v12, v31, v4 row_newbcast:12 row_mask:0xf bank_mask:0xf
    v_and_b32_dpp v13, v31, v5 row_newbcast:12 row_mask:0xf bank_mask:0xf
    v_and_b32_dpp v14, v31, v6 row_newbcast:12 row_mask:0xf bank_mask:0xf
    v_and_b32_dpp v15, v31, v7 row_newbcast:12 row_mask:0xf bank_mask:0xf
    s_waitcnt vmcnt(5)
    buffer_load_dwordx4 v[124:127], v2, s[48:51], s69 offen offset:1024 nt
    v_mfma_f32_16x16x32_bf16 v[16:19], v[12:15], v[100:103], v[16:19]
    v_and_b32_dpp v8, v32, v4 row_newbcast:0 row_mask:0xf bank_mask:0xf
    v_and_b32_dpp v9, v32, v5 row_newbcast:0 row_mask:0xf bank_mask:0xf
    v_and_b32_dpp v10, v32, v6 row_newbcast:0 row_mask:0xf bank_mask:0xf
    v_and_b32_dpp v11, v32, v7 row_newbcast:0 row_mask:0xf bank_mask:0xf
    s_waitcnt vmcnt(5)
    buffer_load_dwordx4 v[128:131], v2, s[48:51], s69 offen offset:2048 nt
    v_mfma_f32_16x16x32_bf16 v[16:19], v[8:11], v[104:107], v[16:19]
    v_and_b32_dpp v12, v32, v4 row_newbcast:4 row_mask:0xf bank_mask:0xf
    v_and_b32_dpp v13, v32, v5 row_newbcast:4 row_mask:0xf bank_mask:0xf
    v_and_b32_dpp v14, v32, v6 row_newbcast:4 row_mask:0xf bank_mask:0xf
    v_and_b32_dpp v15, v32, v7 row_newbcast:4 row_mask:0xf bank_mask:0xf
    s_waitcnt vmcnt(5)
    buffer_load_dwordx4 v[132:135], v2, s[48:51], s69 offen offset:3072 nt
    v_mfma_f32_16x16x32_bf16 v[16:19], v[12:15], v[108:111], v[16:19]
    v_and_b32_dpp v8, v32, v4 row_newbcast:8 row_mask:0xf bank_mask:0xf
    v_and_b32_dpp v9, v32, v5 row_newbcast:8 row_mask:0xf bank_mask:0xf
    v_and_b32_dpp v10, v32, v6 row_newbcast:8 row_mask:0xf bank_mask:0xf
    v_and_b32_dpp v11, v32, v7 row_newbcast:8 row_mask:0xf bank_mask:0xf
    s_waitcnt vmcnt(5)
    buffer_load_dwordx4 v[136:139], v2, s[48:51], s70 offen offset:0 nt
    v_mfma_f32_16x16x32_bf16 v[16:19], v[8:11], v[112:115], v[16:19]
    v_and_b32_dpp v12, v32, v4 row_newbcast:12 row_mask:0xf bank_mask:0xf
    v_and_b32_dpp v13, v32, v5 row_newbcast:12 row_mask:0xf bank_mask:0xf
    v_and_b32_dpp v14, v32, v6 row_newbcast:12 row_mask:0xf bank_mask:0xf
    v_and_b32_dpp v15, v32, v7 row_newbcast:12 row_mask:0xf bank_mask:0xf
    s_waitcnt vmcnt(5)
    buffer_load_dwordx4 v[140:143], v2, s[48:51], s70 offen offset:1024 nt
    v_mfma_f32_16x16x32_bf16 v[16:19], v[12:15], v[116:119], v[16:19]
    v_and_b32_dpp v8, v33, v4 row_newbcast:0 row_mask:0xf bank_mask:0xf
    v_and_b32_dpp v9, v33, v5 row_newbcast:0 row_mask:0xf bank_mask:0xf
    v_and_b32_dpp v10, v33, v6 row_newbcast:0 row_mask:0xf bank_mask:0xf
    v_and_b32_dpp v11, v33, v7 row_newbcast:0 row_mask:0xf bank_mask:0xf
    s_waitcnt vmcnt(5)
    buffer_load_dwordx4 v[144:147], v2, s[48:51], s70 offen offset:2048 nt
    v_mfma_f32_16x16x32_bf16 v[16:19], v[8:11], v[120:123], v[16:19]
    v_and_b32_dpp v12, v33, v4 row_newbcast:4 row_mask:0xf bank_mask:0xf
    v_and_b32_dpp v13, v33, v5 row_newbcast:4 row_mask:0xf bank_mask:0xf
    v_and_b32_dpp v14, v33, v6 row_newbcast:4 row_mask:0xf bank_mask:0xf
    v_and_b32_dpp v15, v33, v7 row_newbcast:4 row_mask:0xf bank_mask:0xf
    s_waitcnt vmcnt(5)
    buffer_load_dwordx4 v[148:151], v2, s[48:51], s70 offen offset:3072 nt
    v_mfma_f32_16x16x32_bf16 v[16:19], v[12:15], v[124:127], v[16:19]
    v_and_b32_dpp v8, v33, v4 row_newbcast:8 row_mask:0xf bank_mask:0xf
    v_and_b32_dpp v9, v33, v5 row_newbcast:8 row_mask:0xf bank_mask:0xf
    v_and_b32_dpp v10, v33, v6 row_newbcast:8 row_mask:0xf bank_mask:0xf
    v_and_b32_dpp v11, v33, v7 row_newbcast:8 row_mask:0xf bank_mask:0xf
    s_waitcnt vmcnt(5)
    buffer_load_dwordx4 v[152:155], v2, s[48:51], s71 offen offset:0 nt
    v_mfma_f32_16x16x32_bf16 v[16:19], v[8:11], v[128:131], v[16:19]
    v_and_b32_dpp v12, v33, v4 row_newbcast:12 row_mask:0xf bank_mask:0xf
    v_and_b32_dpp v13, v33, v5 row_newbcast:12 row_mask:0xf bank_mask:0xf
    v_and_b32_dpp v14, v33, v6 row_newbcast:12 row_mask:0xf bank_mask:0xf
    v_and_b32_dpp v15, v33, v7 row_newbcast:12 row_mask:0xf bank_mask:0xf
    s_waitcnt vmcnt(5)
    buffer_load_dwordx4 v[156:159], v2, s[48:51], s71 offen offset:1024 nt
    v_mfma_f32_16x16x32_bf16 v[16:19], v[12:15], v[132:135], v[16:19]
    v_and_b32_dpp v8, v34, v4 row_newbcast:0 row_mask:0xf bank_mask:0xf
    v_and_b32_dpp v9, v34, v5 row_newbcast:0 row_mask:0xf bank_mask:0xf
    v_and_b32_dpp v10, v34, v6 row_newbcast:0 row_mask:0xf bank_mask:0xf
    v_and_b32_dpp v11, v34, v7 row_newbcast:0 row_mask:0xf bank_mask:0xf
    s_waitcnt vmcnt(5)
    buffer_load_dwordx4 v[160:163], v2, s[48:51], s71 offen offset:2048 nt
    v_mfma_f32_16x16x32_bf16 v[16:19], v[8:11], v[136:139], v[16:19]
    v_and_b32_dpp v12, v34, v4 row_newbcast:4 row_mask:0xf bank_mask:0xf
    v_and_b32_dpp v13, v34, v5 row_newbcast:4 row_mask:0xf bank_mask:0xf
    v_and_b32_dpp v14, v34, v6 row_newbcast:4 row_mask:0xf bank_mask:0xf
    v_and_b32_dpp v15, v34, v7 row_newbcast:4 row_mask:0xf bank_mask:0xf
    s_waitcnt vmcnt(5)
    buffer_load_dwordx4 v[164:167], v2, s[48:51], s71 offen offset:3072 nt
    v_mfma_f32_16x16x32_bf16 v[16:19], v[12:15], v[140:143], v[16:19]
    v_and_b32_dpp v8, v34, v4 row_newbcast:8 row_mask:0xf bank_mask:0xf
    v_and_b32_dpp v9, v34, v5 row_newbcast:8 row_mask:0xf bank_mask:0xf
    v_and_b32_dpp v10, v34, v6 row_newbcast:8 row_mask:0xf bank_mask:0xf
    v_and_b32_dpp v11, v34, v7 row_newbcast:8 row_mask:0xf bank_mask:0xf
    v_mov_b32 v36, 1
    s_mov_b64 exec, 1
    ds_add_u32 v3, v36 offset:40
    s_mov_b64 exec, -1
    s_waitcnt vmcnt(5)
    v_mfma_f32_16x16x32_bf16 v[16:19], v[8:11], v[144:147], v[16:19]
    v_and_b32_dpp v12, v34, v4 row_newbcast:12 row_mask:0xf bank_mask:0xf
    v_and_b32_dpp v13, v34, v5 row_newbcast:12 row_mask:0xf bank_mask:0xf
    v_and_b32_dpp v14, v34, v6 row_newbcast:12 row_mask:0xf bank_mask:0xf
    v_and_b32_dpp v15, v34, v7 row_newbcast:12 row_mask:0xf bank_mask:0xf
    s_waitcnt vmcnt(4)
    s_nop 0
    v_mfma_f32_16x16x32_bf16 v[16:19], v[12:15], v[148:151], v[16:19]
    v_and_b32_dpp v8, v35, v4 row_newbcast:0 row_mask:0xf bank_mask:0xf
    v_and_b32_dpp v9, v35, v5 row_newbcast:0 row_mask:0xf bank_mask:0xf
    v_and_b32_dpp v10, v35, v6 row_newbcast:0 row_mask:0xf bank_mask:0xf
    v_and_b32_dpp v11, v35, v7 row_newbcast:0 row_mask:0xf bank_mask:0xf
    s_waitcnt vmcnt(3)
    s_nop 0
    v_mfma_f32_16x16x32_bf16 v[16:19], v[8:11], v[152:155], v[16:19]
    v_and_b32_dpp v12, v35, v4 row_newbcast:4 row_mask:0xf bank_mask:0xf
    v_and_b32_dpp v13, v35, v5 row_newbcast:4 row_mask:0xf bank_mask:0xf
    v_and_b32_dpp v14, v35, v6 row_newbcast:4 row_mask:0xf bank_mask:0xf
    v_and_b32_dpp v15, v35, v7 row_newbcast:4 row_mask:0xf bank_mask:0xf
    s_waitcnt vmcnt(2)
    s_nop 0
    v_mfma_f32_16x16x32_bf16 v[16:19], v[12:15], v[156:159], v[16:19]
    v_and_b32_dpp v8, v35, v4 row_newbcast:8 row_mask:0xf bank_mask:0xf
    v_and_b32_dpp v9, v35, v5 row_newbcast:8 row_mask:0xf bank_mask:0xf
    v_and_b32_dpp v10, v35, v6 row_newbcast:8 row_mask:0xf bank_mask:0xf
    v_and_b32_dpp v11, v35, v7 row_newbcast:8 row_mask:0xf bank_mask:0xf
    s_waitcnt vmcnt(1)
    s_nop 0
    v_mfma_f32_16x16x32_bf16 v[16:19], v[8:11], v[160:163], v[16:19]
    v_and_b32_dpp v12, v35, v4 row_newbcast:12 row_mask:0xf bank_mask:0xf
    v_and_b32_dpp v13, v35, v5 row_newbcast:12 row_mask:0xf bank_mask:0xf
    v_and_b32_dpp v14, v35, v6 row_newbcast:12 row_mask:0xf bank_mask:0xf
    v_and_b32_dpp v15, v35, v7 row_newbcast:12 row_mask:0xf bank_mask:0xf
    s_waitcnt vmcnt(0)
    s_nop 0
    v_mfma_f32_16x16x32_bf16 v[16:19], v[12:15], v[164:167], v[16:19]
    s_mov_b32 exec_hi, 0
    s_nop 6
    ds_write_b128 v20, v[16:19]
    v_mov_b32 v36, 1
    s_mov_b64 exec, 1
    ds_add_rtn_u32 v37, v3, v36 offset:16
    s_mov_b64 exec, -1
    s_waitcnt lgkmcnt(0)
    v_readfirstlane_b32 s14, v37
    s_nop 0
    s_cmp_lg_u32 s14, 7
    s_cbranch_scc1 L_sexit_a
    s_mov_b32 s15, 65536
L_oread_56:
    ds_read_b32 v39, v3 offset:12
    ds_read_b32 v36, v3 offset:44
    ds_read_b128 v[4:7], v22
    ds_read_b128 v[40:43], v21 offset:0
    ds_read_b128 v[44:47], v21 offset:512
    ds_read_b128 v[48:51], v21 offset:1024
    ds_read_b128 v[52:55], v21 offset:1536
    s_waitcnt lgkmcnt(4)
    v_readfirstlane_b32 s14, v39
    s_nop 0
    s_cmp_lg_u32 s14, 0
    s_cbranch_scc1 L_oread_56_ok
    s_waitcnt lgkmcnt(0)
    s_sub_u32 s15, s15, 1
    s_cmp_eq_u32 s15, 0
    s_cbranch_scc0 L_oread_56
    s_branch L_abort
L_oread_56_ok:
    v_readfirstlane_b32 s63, v36
    s_waitcnt lgkmcnt(3)
    v_mul_f32 v8, v4, v40
    v_mul_f32 v9, v4, v41
    v_mul_f32 v10, v4, v42
    v_mul_f32 v11, v4, v43
    s_waitcnt lgkmcnt(2)
    v_fmac_f32 v8, v5, v44
    v_fmac_f32 v9, v5, v45
    v_fmac_f32 v10, v5, v46
    v_fmac_f32 v11, v5, v47
    s_waitcnt lgkmcnt(1)
    v_fmac_f32 v8, v6, v48
    v_fmac_f32 v9, v6, v49
    v_fmac_f32 v10, v6, v50
    v_fmac_f32 v11, v6, v51
    s_waitcnt lgkmcnt(0)
    v_fmac_f32 v8, v7, v52
    v_fmac_f32 v9, v7, v53
    v_fmac_f32 v10, v7, v54
    v_fmac_f32 v11, v7, v55
    v_mov_b32 v12, v8
    v_mov_b32 v13, v9
    v_mov_b32 v14, v10
    v_mov_b32 v15, v11
    v_permlane32_swap_b32 v8, v12
    v_permlane32_swap_b32 v9, v13
    v_permlane32_swap_b32 v10, v14
    v_permlane32_swap_b32 v11, v15
    v_add_f32 v8, v8, v12
    v_add_f32 v9, v9, v13
    v_add_f32 v10, v10, v14
    v_add_f32 v11, v11, v15
    v_bfi_b32 v8, s76, v8, v24
    v_bfi_b32 v9, s76, v9, v25
    v_bfi_b32 v10, s76, v10, v26
    v_bfi_b32 v11, s76, v11, v27
    s_lshl_b32 s10, s4, 3
    s_add_u32 s10, s10, s7
    s_lshl_b32 s10, s10, 9
    s_add_u32 s62, s10, 458752
    s_mov_b32 exec_hi, 0
    s_cmp_eq_u32 s63, 1
    s_cbranch_scc0 L_stw_57
    buffer_store_dwordx4 v[8:11], v23, s[52:55], s62 offen
    s_branch L_std_58
L_stw_57:
    buffer_store_dwordx4 v[8:11], v23, s[52:55], s62 offen sc1
L_std_58:
    s_mov_b64 exec, -1
    v_mov_b32 v36, 1
    s_mov_b64 exec, 1
    ds_write_b32 v3, v36 offset:24
    s_mov_b64 exec, -1
    s_cmp_eq_u32 s59, 0
    s_cbranch_scc1 L_sexit_a
    v_lshrrev_b32 v4, 5, v0
    v_mul_u32_u24 v5, 272, v4
    v_lshlrev_b32 v4, 11, v4
    v_add_u32 v4, v4, v23
    v_lshrrev_b32 v6, 1, v23
    v_add_u32 v5, v5, v6
    v_add_u32 v5, 137216, v5
    s_lshl_b32 s62, s4, 12
    s_add_u32 s62, s62, 458752
    s_mov_b64 s[64:65], -1
    s_mov_b64 s[66:67], -1
    s_mov_b64 s[68:69], -1
    s_mov_b64 s[70:71], -1
    s_mov_b32 s15, 65536
    s_mov_b64 exec, s[64:65]
    buffer_load_dwordx4 v[40:43], v4, s[52:55], s62 offen sc1
    s_mov_b64 exec, s[66:67]
    s_add_u32 s13, s62, 512
    buffer_load_dwordx4 v[44:47], v4, s[52:55], s13 offen sc1
    s_mov_b64 exec, s[68:69]
    s_add_u32 s13, s62, 1024
    buffer_load_dwordx4 v[48:51], v4, s[52:55], s13 offen sc1
    s_mov_b64 exec, s[70:71]
    s_add_u32 s13, s62, 1536
    buffer_load_dwordx4 v[52:55], v4, s[52:55], s13 offen sc1
    s_mov_b64 exec, -1
    s_sleep 4
L_ppoll_59:
    s_mov_b64 exec, s[64:65]
    buffer_load_dwordx4 v[40:43], v4, s[52:55], s62 offen sc1
    s_mov_b64 exec, s[66:67]
    s_add_u32 s13, s62, 512
    buffer_load_dwordx4 v[44:47], v4, s[52:55], s13 offen sc1
    s_mov_b64 exec, s[68:69]
    s_add_u32 s13, s62, 1024
    buffer_load_dwordx4 v[48:51], v4, s[52:55], s13 offen sc1
    s_mov_b64 exec, s[70:71]
    s_add_u32 s13, s62, 1536
    buffer_load_dwordx4 v[52:55], v4, s[52:55], s13 offen sc1
    s_mov_b64 exec, -1
    s_waitcnt vmcnt(4)
    v_perm_b32 v6, v41, v40, s73
    v_perm_b32 v7, v43, v42, s74
    v_or_b32 v6, v6, v7
    v_cmp_ne_u32 s[64:65], s43, v6
    v_perm_b32 v6, v45, v44, s73
    v_perm_b32 v7, v47, v46, s74
    v_or_b32 v6, v6, v7
    v_cmp_ne_u32 s[66:67], s43, v6
    v_perm_b32 v6, v49, v48, s73
    v_perm_b32 v7, v51, v50, s74
    v_or_b32 v6, v6, v7
    v_cmp_ne_u32 s[68:69], s43, v6
    v_perm_b32 v6, v53, v52, s73
    v_perm_b32 v7, v55, v54, s74
    v_or_b32 v6, v6, v7
    v_cmp_ne_u32 s[70:71], s43, v6
    s_or_b64 s[10:11], s[64:65], s[66:67]
    s_or_b64 s[10:11], s[10:11], s[68:69]
    s_or_b64 s[10:11], s[10:11], s[70:71]
    s_cmp_eq_u64 s[10:11], 0
    s_cbranch_scc1 L_ppolld_60
    s_sub_u32 s15, s15, 1
    s_cmp_eq_u32 s15, 0
    s_cbranch_scc0 L_ppoll_59
    s_branch L_abort
L_ppolld_60:
    v_and_b32 v64, s76, v40
    v_and_b32 v65, s76, v41
    v_and_b32 v66, s76, v42
    v_and_b32 v67, s76, v43
    v_and_b32 v68, s76, v44
    v_and_b32 v69, s76, v45
    v_and_b32 v70, s76, v46
    v_and_b32 v71, s76, v47
    v_and_b32 v72, s76, v48
    v_and_b32 v73, s76, v49
    v_and_b32 v74, s76, v50
    v_and_b32 v75, s76, v51
    v_and_b32 v76, s76, v52
    v_and_b32 v77, s76, v53
    v_and_b32 v78, s76, v54
    v_and_b32 v79, s76, v55
    v_add_f32 v60, v64, v68
    v_add_f32 v61, v65, v69
    v_add_f32 v62, v66, v70
    v_add_f32 v63, v67, v71
    v_add_f32 v80, v72, v76
    v_add_f32 v81, v73, v77
    v_add_f32 v82, v74, v78
    v_add_f32 v83, v75, v79
    v_add_f32 v60, v60, v80
    v_add_f32 v61, v61, v81
    v_add_f32 v62, v62, v82
    v_add_f32 v63, v63, v83
    v_cvt_pk_bf16_f32 v60, v60, v61
    v_cvt_pk_bf16_f32 v61, v62, v63
    ds_write_b64 v5, v[60:61]
    s_waitcnt lgkmcnt(0)
    s_barrier
L_sexit_a:
    s_endpgm
L_abort:
L_exit:
    s_endpgm
L_end:
.section .rodata,"a"
.p2align 6
.amdhsa_kernel adaLN_cond__gqa_block_cached__dense_activation_silu__decode_kernel
  .amdhsa_next_free_vgpr 168
  .amdhsa_next_free_sgpr 102
  .amdhsa_accum_offset 168
  .amdhsa_group_segment_fixed_size 0
  .amdhsa_kernarg_size 104
  .amdhsa_user_sgpr_count 2
  .amdhsa_user_sgpr_kernarg_segment_ptr 1
  .amdhsa_system_sgpr_workgroup_id_x 1
.end_amdhsa_kernel
```
